```python
import torch

def _softmax(x, axis=-1):
    return torch.softmax(x, dim=axis)
def _gelu(x):
    return torch.nn.functional.gelu(x, approximate="tanh")
def _silu(x):
    return torch.nn.functional.silu(x)
def _sigmoid(x):
    return torch.sigmoid(x)
def _layernorm(x, axis=-1, eps=1e-5):
    m = x.mean(dim=axis, keepdim=True)
    v = x.var(dim=axis, keepdim=True, unbiased=False)
    return (x - m) / torch.sqrt(v + eps)
def _scatter_add(tgt, idx, src, axis=0):
    return tgt.clone().index_add_(axis, idx, src)
def _segment_sum(src, seg, n):
    out = torch.zeros((n,) + src.shape[1:], dtype=src.dtype)
    return out.index_add_(0, seg, src)
def _pad(x, pw):
    flat = tuple(v for pair in reversed(pw) for v in pair)
    return torch.nn.functional.pad(x, flat)

kernel_name = 'recurrent_scan__sliding_block__dense_activation_relu__prompt'

def setup_inputs():

    _w = (lambda a: (lambda t: t.to(torch.bfloat16) if t.is_floating_point() else t)(torch.as_tensor(a)))
    def _A_setup():
        B, S, D = 1, 2048, 512
        return {
            "x": _w((lambda *s: torch.randn(*s, dtype=torch.bfloat16) * 0.05)(B, S, D)),
            "wqkv": _w((lambda *s: torch.randn(*s, dtype=torch.bfloat16) * 0.05)(D, 3 * D)),
            "wo": _w((lambda *s: torch.randn(*s, dtype=torch.bfloat16) * 0.05)(D, D)),
        }
    _A_in = _A_setup()

    def _B_setup():
        B, S, D, Dff = 1, 2048, 512, 1792
        return {
            "x": _w((lambda *s: torch.randn(*s, dtype=torch.bfloat16) * 0.05)(B, S, D)),
            "w1": _w((lambda *s: torch.randn(*s, dtype=torch.bfloat16) * 0.05)(D, Dff)),
            "w2": _w((lambda *s: torch.randn(*s, dtype=torch.bfloat16) * 0.05)(Dff, D)),
        }
    _B_in = _B_setup()

    return {
        "A_x": _A_in["x"],
        "A_wqkv": _A_in["wqkv"],
        "A_wo": _A_in["wo"],
        "B_x": _B_in["x"],
        "B_w1": _B_in["w1"],
        "B_w2": _B_in["w2"],
    }

def reference(A_x, A_wqkv, A_wo, B_x, B_w1, B_w2):
    def _A_ref(x, wqkv, wo):
        B, S, D = x.shape
        H = 32; Dh = D // H; W = 256
        qkv = (lambda x, *d: x.permute(*d))((x @ wqkv).reshape(B, S, 3, H, Dh), 2, 0, 3, 1, 4)
        q, k, v = qkv[0], qkv[1], qkv[2]
        scores = torch.einsum("bhqd,bhkd->bhqk", q, k) * (Dh ** -0.5)
        idx = torch.arange(S)
        mask = (idx[:, None] - idx[None, :] >= 0) & (idx[:, None] - idx[None, :] < W)
        scores = torch.where(mask[None, None], scores, -1e9)
        p = _softmax(scores, axis=-1)
        o = torch.einsum("bhqk,bhkd->bhqd", p, v)
        return (lambda x, *d: x.permute(*d))(o, 0, 2, 1, 3).reshape(B, S, D) @ wo

    def _B_ref(x, w1, w2):
        h = torch.einsum("bsd,df->bsf", x, w1)
        zero = torch.zeros_like(h)
        h = torch.maximum(h, zero)
        return torch.einsum("bsf,fd->bsd", h, w2)

    x = A_x
    xn = _layernorm(x, axis=-1)
    s = _A_ref(xn, A_wqkv, A_wo)
    g = _silu(_B_ref(xn, B_w1, B_w2))
    return x + s * g
```

```asm
; @launch grid=(256,1,1) block=(256,1,1) lds=163840
.amdgcn_target "amdgcn-amd-amdhsa--gfx950"
.text
.globl recurrent_scan__sliding_block__dense_activation_relu__prompt_kernel
.p2align 8
.type recurrent_scan__sliding_block__dense_activation_relu__prompt_kernel,@function
recurrent_scan__sliding_block__dense_activation_relu__prompt_kernel:
s_cmp_ge_u32 s2, 256
s_cbranch_scc1 recurrent_scan__sliding_block__dense_activation_relu__prompt_kernel_done
s_load_dwordx4 s[20:23], s[0:1], 0
s_load_dwordx2 s[12:13], s[0:1], 16
s_load_dwordx4 s[24:27], s[0:1], 32
s_load_dwordx2 s[14:15], s[0:1], 48
s_load_dwordx2 s[4:5], s[0:1], 64
v_lshrrev_b32 v2, 6, v0
v_and_b32 v1, 63, v0
v_readfirstlane_b32 s16, v2
s_and_b32 s18, s2, 7
s_lshr_b32 s19, s2, 3
s_and_b32 s52, s18, 1
s_lshl_b32 s52, s52, 3
s_and_b32 s57, s19, 7
s_xor_b32 s57, s57, 0
s_add_u32 s44, s52, s57
s_lshr_b32 s52, s18, 1
s_lshl_b32 s52, s52, 2
s_lshr_b32 s57, s19, 3
s_add_u32 s45, s52, s57
s_getpc_b64 s[60:61]
Lpc0:
s_lshl_b32 s52, s19, 2
s_add_u32 s52, s52, s16
s_lshl_b32 s52, s52, 8
v_and_b32 v220, 1, v1
v_lshlrev_b32 v220, 7, v220
v_add_u32 v220, s52, v220
v_min_u32 v220, Lend-Lpc0-4, v220
v_and_b32 v220, 0xfffffffc, v220
global_load_dword v245, v220, s[60:61]
s_lshr_b32 s52, s19, 3
s_lshl_b32 s52, s52, 1
s_add_u32 s52, s52, s19
s_and_b32 s52, s52, 7
s_add_u32 s57, s52, 0
s_and_b32 s62, s57, 7
s_add_u32 s57, s52, 1
s_and_b32 s63, s57, 7
s_add_u32 s57, s52, 2
s_and_b32 s64, s57, 7
s_add_u32 s57, s52, 3
s_and_b32 s65, s57, 7
s_add_u32 s57, s52, 4
s_and_b32 s66, s57, 7
s_add_u32 s57, s52, 5
s_and_b32 s67, s57, 7
s_add_u32 s57, s52, 6
s_and_b32 s68, s57, 7
s_add_u32 s57, s52, 7
s_and_b32 s69, s57, 7
s_lshl_b32 s46, s16, 12
s_mul_i32 s47, s16, 3072
s_add_u32 s47, s47, 16384
s_lshl_b32 s48, s16, 15
s_mul_i32 s49, s16, 49152
s_mul_i32 s50, s16, 57344
s_lshl_b32 s51, s44, 2
s_add_u32 s51, s51, s16
v_lshlrev_b32 v241, 4, v1
v_lshrrev_b32 v220, 3, v1
v_lshlrev_b32 v220, 10, v220
v_add_u32 v220, s48, v220
v_and_b32 v221, 7, v1
v_bfe_u32 v222, v1, 4, 2
v_xor_b32 v221, v221, v222
v_xor_b32 v223, 0, v221
v_lshlrev_b32 v223, 4, v223
v_add_u32 v223, v223, v220
v_add_u32 v2, 0, v223
v_xor_b32 v223, 4, v221
v_lshlrev_b32 v223, 4, v223
v_add_u32 v223, v223, v220
v_add_u32 v3, 7168, v223
v_xor_b32 v223, 0, v221
v_lshlrev_b32 v223, 4, v223
v_add_u32 v223, v223, v220
v_add_u32 v4, 14336, v223
v_xor_b32 v223, 4, v221
v_lshlrev_b32 v223, 4, v223
v_add_u32 v223, v223, v220
v_add_u32 v5, 21504, v223
s_mov_b32 s52, 43691
v_add_u32 v220, 0, v1
v_mul_u32_u24 v221, s52, v220
v_lshrrev_b32 v221, 19, v221
v_mul_u32_u24 v222, 12, v221
v_sub_u32 v222, v220, v222
v_lshlrev_b32 v222, 4, v222
v_mul_u32_u24 v221, 0xc00, v221
v_add3_u32 v221, v221, v222, s49
v_subrev_u32 v6, 0, v221
v_add_u32 v220, 64, v1
v_mul_u32_u24 v221, s52, v220
v_lshrrev_b32 v221, 19, v221
v_mul_u32_u24 v222, 12, v221
v_sub_u32 v222, v220, v222
v_lshlrev_b32 v222, 4, v222
v_mul_u32_u24 v221, 0xc00, v221
v_add3_u32 v221, v221, v222, s49
v_subrev_u32 v7, 1024, v221
v_add_u32 v220, 128, v1
v_mul_u32_u24 v221, s52, v220
v_lshrrev_b32 v221, 19, v221
v_mul_u32_u24 v222, 12, v221
v_sub_u32 v222, v220, v222
v_lshlrev_b32 v222, 4, v222
v_mul_u32_u24 v221, 0xc00, v221
v_add3_u32 v221, v221, v222, s49
v_subrev_u32 v8, 2048, v221
s_waitcnt lgkmcnt(0)
s_lshl_b32 s52, s44, 17
s_add_u32 s32, s20, s52
s_addc_u32 s33, s21, 0
s_mov_b32 s34, 0x20000
s_mov_b32 s35, 0x20000
s_mul_i32 s52, s45, 192
s_add_u32 s36, s22, s52
s_addc_u32 s37, s23, 0
s_sub_u32 s38, 1572864, s52
s_mov_b32 s39, 0x20000
s_lshl_b32 s52, s45, 13
s_lshl_b32 s57, s16, 11
s_add_u32 s52, s52, s57
s_mov_b32 s31, s52
s_lshl_b32 s100, s62, 7
s_add_u32 m0, s46, 0
s_nop 0
buffer_load_dwordx4 v2, s[32:35], s100 offen offset:0 lds
buffer_load_dwordx4 v3, s[32:35], s100 offen offset:1024 lds
buffer_load_dwordx4 v4, s[32:35], s100 offen offset:2048 lds
buffer_load_dwordx4 v5, s[32:35], s100 offen offset:3072 lds
s_mul_i32 s101, s62, 196608
s_add_u32 m0, s47, 0
s_nop 0
buffer_load_dwordx4 v6, s[36:39], s101 offen offset:0 lds
buffer_load_dwordx4 v7, s[36:39], s101 offen offset:1024 lds
buffer_load_dwordx4 v8, s[36:39], s101 offen offset:2048 lds
buffer_load_dwordx4 v[204:207], v241, s[32:35], s31 offen
buffer_load_dwordx4 v[208:211], v241, s[32:35], s31 offen offset:1024
s_mov_b32 s6, 0x1100000
s_mov_b32 s7, 0x20000
s_add_u32 s60, s4, 0xf19000
s_addc_u32 s61, s5, 0
s_load_dword s17, s[60:61], 0
s_mov_b32 s8, s20
s_mov_b32 s9, s21
s_mov_b32 s10, s26
s_mov_b32 s11, s27
s_lshr_b32 s52, s45, 2
s_mul_i32 s52, s52, 7
s_and_b32 s57, s45, 3
s_cmp_eq_u32 s57, 3
s_cselect_b32 s3, 1, 0
s_lshl_b32 s57, s57, 1
s_add_u32 s53, s52, s57
s_lshl_b32 s100, s63, 7
s_add_u32 m0, s46, 28672
s_nop 0
buffer_load_dwordx4 v2, s[32:35], s100 offen offset:0 lds
s_lshl_b32 s52, s53, 7
s_add_u32 s40, s24, s52
s_addc_u32 s41, s25, 0
s_sub_u32 s42, 1835008, s52
s_mov_b32 s43, 0x20000
s_lshl_b32 s52, s44, 8
s_lshl_b32 s57, s45, 4
s_add_u32 s52, s52, s57
s_lshl_b32 s57, s16, 2
s_add_u32 s52, s52, s57
s_add_u32 s30, s52, 0xf12000
s_lshl_b32 s52, s18, 2
s_and_b32 s57, s19, 3
s_add_u32 s28, s52, s57
s_lshr_b32 s29, s19, 2
s_lshr_b32 s52, s19, 3
buffer_load_dwordx4 v3, s[32:35], s100 offen offset:1024 lds
s_mul_i32 s52, s52, 7
s_add_u32 s52, s52, 1
s_lshr_b32 s52, s52, 1
s_lshl_b32 s52, s52, 12
s_add_u32 s57, s52, 0
s_add_u32 s70, s52, 0xffff2000
s_min_u32 s70, s70, s57
s_add_u32 s57, s52, 4096
s_add_u32 s71, s52, 0xffff3000
s_min_u32 s71, s71, s57
s_add_u32 s57, s52, 8192
s_add_u32 s72, s52, 0xffff4000
s_min_u32 s72, s72, s57
s_add_u32 s57, s52, 12288
s_add_u32 s73, s52, 0xffff5000
s_min_u32 s73, s73, s57
buffer_load_dwordx4 v4, s[32:35], s100 offen offset:2048 lds
s_add_u32 s57, s52, 16384
s_add_u32 s74, s52, 0xffff6000
s_min_u32 s74, s74, s57
s_add_u32 s57, s52, 20480
s_add_u32 s75, s52, 0xffff7000
s_min_u32 s75, s75, s57
s_add_u32 s57, s52, 24576
s_add_u32 s76, s52, 0xffff8000
s_min_u32 s76, s76, s57
s_add_u32 s57, s52, 28672
s_add_u32 s77, s52, 0xffff9000
s_min_u32 s77, s77, s57
s_add_u32 s57, s52, 32768
s_add_u32 s78, s52, 0xffffa000
s_min_u32 s78, s78, s57
s_add_u32 s57, s52, 36864
buffer_load_dwordx4 v5, s[32:35], s100 offen offset:3072 lds
s_add_u32 s79, s52, 0xffffb000
s_min_u32 s79, s79, s57
s_add_u32 s57, s52, 40960
s_add_u32 s80, s52, 0xffffc000
s_min_u32 s80, s80, s57
s_add_u32 s57, s52, 45056
s_add_u32 s81, s52, 0xffffd000
s_min_u32 s81, s81, s57
s_add_u32 s57, s52, 49152
s_add_u32 s82, s52, 0xffffe000
s_min_u32 s82, s82, s57
s_add_u32 s57, s52, 53248
s_add_u32 s83, s52, 0xfffff000
s_min_u32 s83, s83, s57
v_lshrrev_b32 v220, 4, v1
v_mul_u32_u24 v221, 0xe00, v220
s_mul_i32 s101, s63, 196608
s_add_u32 m0, s47, 28672
s_nop 0
buffer_load_dwordx4 v6, s[36:39], s101 offen offset:0 lds
v_bfe_u32 v222, v1, 2, 2
v_xor_b32 v222, v222, v220
v_lshlrev_b32 v222, 6, v222
v_add_u32 v221, v221, v222
v_and_b32 v222, 3, v1
v_lshlrev_b32 v222, 4, v222
v_add3_u32 v221, v221, v222, s50
v_bfe_u32 v222, v1, 2, 2
v_xor_b32 v222, v222, v220
s_lshl_b32 s52, s3, 1
s_sub_u32 s52, 4, s52
v_cmp_le_u32 s[20:21], s52, v222
v_mov_b32 v222, 0x7fe00000
s_nop 0
v_cndmask_b32 v221, v221, v222, s[20:21]
v_add_u32 v9, 0, v221
v_add_u32 v10, 13312, v221
buffer_load_dwordx4 v7, s[36:39], s101 offen offset:1024 lds
v_add_u32 v11, 26624, v221
v_add_u32 v12, 39936, v221
v_and_b32 v220, 31, v1
v_lshrrev_b32 v221, 3, v220
v_lshlrev_b32 v221, 10, v221
v_and_b32 v222, 7, v220
v_lshlrev_b32 v222, 7, v222
v_add_u32 v221, v221, v222
v_bfe_u32 v222, v220, 1, 3
v_lshrrev_b32 v223, 5, v1
v_xor_b32 v222, v222, v223
v_lshlrev_b32 v222, 4, v222
v_add_u32 v221, v221, v222
v_add_u32 v221, s46, v221
v_xor_b32 v13, 0, v221
v_add_u32 v17, 57344, v13
buffer_load_dwordx4 v8, s[36:39], s101 offen offset:2048 lds
v_add_u32 v21, 114688, v13
v_xor_b32 v14, 32, v221
v_add_u32 v18, 57344, v14
v_add_u32 v22, 114688, v14
v_xor_b32 v15, 64, v221
v_add_u32 v19, 57344, v15
v_add_u32 v23, 114688, v15
v_xor_b32 v16, 96, v221
v_add_u32 v20, 57344, v16
v_add_u32 v24, 114688, v16
v_bfe_u32 v220, v1, 2, 2
v_and_b32 v221, 3, v1
v_bfe_u32 v222, v1, 4, 1
v_lshrrev_b32 v223, 5, v1
v_lshlrev_b32 v224, 3, v223
v_add_u32 v224, v224, v220
s_lshl_b32 s100, s64, 7
s_add_u32 m0, s46, 57344
s_nop 0
buffer_load_dwordx4 v2, s[32:35], s100 offen offset:0 lds
v_lshlrev_b32 v222, 5, v222
v_lshlrev_b32 v221, 3, v221
v_add_u32 v221, v221, v222
v_mul_u32_u24 v225, 192, v224
v_add_u32 v225, v225, v221
s_add_u32 s52, s16, 0
s_cmp_ge_u32 s52, 3
s_cselect_b32 s57, 3, 0
s_sub_u32 s52, s52, s57
s_cmp_ge_u32 s52, 3
s_cselect_b32 s57, 3, 0
s_sub_u32 s54, s52, s57
s_lshl_b32 s52, s54, 6
s_add_u32 s52, s52, 16384
v_add_u32 v25, s52, v225
v_add_u32 v28, 57344, v25
buffer_load_dwordx4 v3, s[32:35], s100 offen offset:1024 lds
v_add_u32 v31, 114688, v25
s_add_u32 s52, s16, 1
s_cmp_ge_u32 s52, 3
s_cselect_b32 s57, 3, 0
s_sub_u32 s52, s52, s57
s_cmp_ge_u32 s52, 3
s_cselect_b32 s57, 3, 0
s_sub_u32 s55, s52, s57
s_lshl_b32 s52, s55, 6
s_add_u32 s52, s52, 16384
v_add_u32 v26, s52, v225
v_add_u32 v29, 57344, v26
v_add_u32 v32, 114688, v26
s_add_u32 s52, s16, 2
s_cmp_ge_u32 s52, 3
s_cselect_b32 s57, 3, 0
buffer_load_dwordx4 v4, s[32:35], s100 offen offset:2048 lds
s_sub_u32 s52, s52, s57
s_cmp_ge_u32 s52, 3
s_cselect_b32 s57, 3, 0
s_sub_u32 s56, s52, s57
s_lshl_b32 s52, s56, 6
s_add_u32 s52, s52, 16384
v_add_u32 v27, s52, v225
v_add_u32 v30, 57344, v27
v_add_u32 v33, 114688, v27
v_lshlrev_b32 v225, 8, v224
v_add_u32 v225, v225, v221
s_add_u32 s52, s16, 0
s_and_b32 s58, s52, 3
v_xor_b32 v224, s58, v220
v_lshlrev_b32 v224, 6, v224
v_add_u32 v34, v224, v225
buffer_load_dwordx4 v5, s[32:35], s100 offen offset:3072 lds
v_add_u32 v38, 57344, v34
v_add_u32 v42, 114688, v34
s_add_u32 s52, s16, 1
s_and_b32 s59, s52, 3
v_xor_b32 v224, s59, v220
v_lshlrev_b32 v224, 6, v224
v_add_u32 v35, v224, v225
v_add_u32 v39, 57344, v35
v_add_u32 v43, 114688, v35
s_add_u32 s52, s16, 2
s_and_b32 s60, s52, 3
v_xor_b32 v224, s60, v220
v_lshlrev_b32 v224, 6, v224
v_add_u32 v36, v224, v225
v_add_u32 v40, 57344, v36
v_add_u32 v44, 114688, v36
s_mul_i32 s101, s64, 196608
s_add_u32 m0, s47, 57344
s_nop 0
buffer_load_dwordx4 v6, s[36:39], s101 offen offset:0 lds
s_add_u32 s52, s16, 3
s_and_b32 s61, s52, 3
v_xor_b32 v224, s61, v220
v_lshlrev_b32 v224, 6, v224
v_add_u32 v37, v224, v225
v_add_u32 v41, 57344, v37
v_add_u32 v45, 114688, v37
v_and_b32 v224, 1, v1
v_bfe_u32 v225, v1, 4, 1
v_cmp_eq_u32 s[20:21], v224, v225
v_mov_b32 v224, 0x3f803f80
v_mov_b32 v225, 0
v_cndmask_b32 v48, v225, v224, s[20:21]
v_cndmask_b32 v49, v225, v224, s[20:21]
v_cndmask_b32 v50, v225, v224, s[20:21]
v_cndmask_b32 v51, v225, v224, s[20:21]
buffer_load_dwordx4 v7, s[36:39], s101 offen offset:1024 lds
v_and_b32 v224, 1, v1
v_lshlrev_b32 v224, 6, v224
v_lshrrev_b32 v225, 4, v1
v_lshlrev_b32 v225, 4, v225
v_add_u32 v224, v224, v225
v_add_u32 v243, 148480, v224
v_lshrrev_b32 v224, 5, v1
v_lshlrev_b32 v224, 4, v224
v_add_u32 v244, 148480, v224
v_and_b32 v224, 31, v1
v_lshlrev_b32 v246, 4, v224
v_lshlrev_b32 v224, 5, v224
v_lshrrev_b32 v225, 5, v1
v_lshlrev_b32 v225, 4, v225
v_add_u32 v242, v224, v225
buffer_load_dwordx4 v8, s[36:39], s101 offen offset:2048 lds
s_waitcnt lgkmcnt(0)
s_add_u32 s17, s17, 0x9e3779b9
s_waitcnt vmcnt(16)
s_barrier
ds_read_b128 a[0:3], v13 offset:0
ds_read_b64_tr_b16 v[60:61], v25 offset:0
ds_read_b64_tr_b16 v[62:63], v25 offset:768
ds_read_b64_tr_b16 v[64:65], v26 offset:0
ds_read_b64_tr_b16 v[66:67], v26 offset:768
ds_read_b64_tr_b16 v[68:69], v27 offset:0
ds_read_b64_tr_b16 v[70:71], v27 offset:768
s_waitcnt lgkmcnt(2)
v_mfma_f32_32x32x16_bf16 v[156:171], v[60:63], a[0:3], 0
ds_read_b128 a[4:7], v14 offset:0
ds_read_b64_tr_b16 v[76:77], v25 offset:3072
ds_read_b64_tr_b16 v[78:79], v25 offset:3840
v_mfma_f32_32x32x16_bf16 v[172:187], v[64:67], a[0:3], 0
ds_read_b64_tr_b16 v[80:81], v26 offset:3072
ds_read_b64_tr_b16 v[82:83], v26 offset:3840
ds_read_b64_tr_b16 v[84:85], v27 offset:3072
ds_read_b64_tr_b16 v[86:87], v27 offset:3840
s_waitcnt lgkmcnt(7)
v_mfma_f32_32x32x16_bf16 v[188:203], v[68:71], a[0:3], 0
s_lshl_b32 s100, s65, 7
s_add_u32 m0, s46, 86016
s_nop 0
buffer_load_dwordx4 v2, s[32:35], s100 offen offset:0 lds
v_mfma_f32_16x16x32_bf16 v[56:59], v[60:63], v[48:51], 0
buffer_load_dwordx4 v3, s[32:35], s100 offen offset:1024 lds
s_waitcnt lgkmcnt(2)
v_mfma_f32_32x32x16_bf16 v[156:171], v[76:79], a[4:7], v[156:171]
ds_read_b128 a[8:11], v15 offset:0
ds_read_b64_tr_b16 v[60:61], v25 offset:6144
ds_read_b64_tr_b16 v[62:63], v25 offset:6912
s_mov_b32 s20, 0x3f803f80
s_waitcnt vmcnt(16)
v_dot2_f32_bf16 v212, v204, s20, 0
v_dot2_f32_bf16 v213, v204, v204, 0
v_mfma_f32_32x32x16_bf16 v[172:187], v[80:83], a[4:7], v[172:187]
ds_read_b64_tr_b16 v[64:65], v26 offset:6144
ds_read_b64_tr_b16 v[66:67], v26 offset:6912
ds_read_b64_tr_b16 v[68:69], v27 offset:6144
ds_read_b64_tr_b16 v[70:71], v27 offset:6912
v_dot2_f32_bf16 v214, v208, s20, 0
v_dot2_f32_bf16 v215, v208, v208, 0
v_dot2_f32_bf16 v212, v205, s20, v212
s_waitcnt lgkmcnt(7)
v_mfma_f32_32x32x16_bf16 v[188:203], v[84:87], a[4:7], v[188:203]
buffer_load_dwordx4 v4, s[32:35], s100 offen offset:2048 lds
v_dot2_f32_bf16 v213, v205, v205, v213
v_dot2_f32_bf16 v214, v209, s20, v214
v_dot2_f32_bf16 v215, v209, v209, v215
v_dot2_f32_bf16 v212, v206, s20, v212
v_dot2_f32_bf16 v213, v206, v206, v213
v_dot2_f32_bf16 v214, v210, s20, v214
v_mfma_f32_16x16x32_bf16 v[56:59], v[76:79], v[48:51], v[56:59]
buffer_load_dwordx4 v5, s[32:35], s100 offen offset:3072 lds
v_dot2_f32_bf16 v215, v210, v210, v215
s_waitcnt lgkmcnt(2)
v_mfma_f32_32x32x16_bf16 v[156:171], v[60:63], a[8:11], v[156:171]
ds_read_b128 a[12:15], v16 offset:0
ds_read_b64_tr_b16 v[76:77], v25 offset:9216
ds_read_b64_tr_b16 v[78:79], v25 offset:9984
v_dot2_f32_bf16 v212, v207, s20, v212
v_dot2_f32_bf16 v213, v207, v207, v213
v_dot2_f32_bf16 v214, v211, s20, v214
v_dot2_f32_bf16 v215, v211, v211, v215
v_mfma_f32_32x32x16_bf16 v[172:187], v[64:67], a[8:11], v[172:187]
ds_read_b64_tr_b16 v[80:81], v26 offset:9216
ds_read_b64_tr_b16 v[82:83], v26 offset:9984
ds_read_b64_tr_b16 v[84:85], v27 offset:9216
ds_read_b64_tr_b16 v[86:87], v27 offset:9984
s_nop 3
v_permlane32_swap_b32 v212, v214
v_permlane32_swap_b32 v213, v215
s_waitcnt lgkmcnt(7)
v_mfma_f32_32x32x16_bf16 v[188:203], v[68:71], a[8:11], v[188:203]
s_mul_i32 s101, s65, 196608
s_add_u32 m0, s47, 86016
s_nop 0
buffer_load_dwordx4 v6, s[36:39], s101 offen offset:0 lds
v_add_f32 v212, v212, v214
v_add_f32 v213, v213, v215
s_nop 0
v_add_f32_dpp v212, v212, v212 row_ror:8 row_mask:0xf bank_mask:0xf
v_add_f32_dpp v213, v213, v213 row_ror:8 row_mask:0xf bank_mask:0xf
v_mfma_f32_16x16x32_bf16 v[56:59], v[60:63], v[48:51], v[56:59]
buffer_load_dwordx4 v7, s[36:39], s101 offen offset:1024 lds
v_add_f32_dpp v212, v212, v212 row_ror:4 row_mask:0xf bank_mask:0xf
s_waitcnt lgkmcnt(0)
s_waitcnt vmcnt(13)
s_barrier
v_mfma_f32_32x32x16_bf16 v[156:171], v[76:79], a[12:15], v[156:171]
ds_read_b128 a[16:19], v13 offset:28672
ds_read_b64_tr_b16 v[60:61], v25 offset:28672
ds_read_b64_tr_b16 v[62:63], v25 offset:29440
v_add_f32_dpp v213, v213, v213 row_ror:4 row_mask:0xf bank_mask:0xf
v_add_f32_dpp v212, v212, v212 row_ror:2 row_mask:0xf bank_mask:0xf
s_nop 0
v_add_f32_dpp v213, v213, v213 row_ror:2 row_mask:0xf bank_mask:0xf
v_add_f32_dpp v212, v212, v212 row_ror:1 row_mask:0xf bank_mask:0xf
v_mfma_f32_32x32x16_bf16 v[172:187], v[80:83], a[12:15], v[172:187]
ds_read_b64_tr_b16 v[64:65], v26 offset:28672
ds_read_b64_tr_b16 v[66:67], v26 offset:29440
ds_read_b64_tr_b16 v[68:69], v27 offset:28672
ds_read_b64_tr_b16 v[70:71], v27 offset:29440
v_add_f32_dpp v213, v213, v213 row_ror:1 row_mask:0xf bank_mask:0xf
v_mov_b32 v214, v212
v_mov_b32 v215, v213
v_mfma_f32_32x32x16_bf16 v[188:203], v[84:87], a[12:15], v[188:203]
buffer_load_dwordx4 v8, s[36:39], s101 offen offset:2048 lds
v_permlane16_swap_b32 v212, v214
v_permlane16_swap_b32 v213, v215
v_add_f32 v212, v212, v214
v_add_f32 v213, v213, v215
v_mul_f32 v204, 0xbb000000, v212
v_mul_f32 v213, 0x3b000000, v213
v_mfma_f32_16x16x32_bf16 v[56:59], v[76:79], v[48:51], v[56:59]
s_lshl_b32 s100, s66, 7
s_add_u32 m0, s46, 114688
s_nop 0
buffer_load_dwordx4 v2, s[32:35], s100 offen offset:0 lds
s_waitcnt lgkmcnt(2)
v_mfma_f32_32x32x16_bf16 v[156:171], v[60:63], a[16:19], v[156:171]
ds_read_b128 a[20:23], v14 offset:28672
ds_read_b64_tr_b16 v[76:77], v25 offset:31744
ds_read_b64_tr_b16 v[78:79], v25 offset:32512
v_fma_f32 v213, -v204, v204, v213
v_max_f32 v213, 0, v213
v_cvt_pk_bf16_f32 v213, v213, v213
v_lshlrev_b32 v213, 16, v213
v_mfma_f32_32x32x16_bf16 v[172:187], v[64:67], a[16:19], v[172:187]
ds_read_b64_tr_b16 v[80:81], v26 offset:31744
ds_read_b64_tr_b16 v[82:83], v26 offset:32512
ds_read_b64_tr_b16 v[84:85], v27 offset:31744
ds_read_b64_tr_b16 v[86:87], v27 offset:32512
v_add_f32 v213, 0x3727c5ac, v213
v_cvt_pk_bf16_f32 v213, v213, v213
v_lshlrev_b32 v213, 16, v213
s_waitcnt lgkmcnt(7)
v_mfma_f32_32x32x16_bf16 v[188:203], v[68:71], a[16:19], v[188:203]
buffer_load_dwordx4 v3, s[32:35], s100 offen offset:1024 lds
v_sqrt_f32 v213, v213
v_mov_b32 v205, s17
v_mov_b32 v207, s17
v_cvt_pk_bf16_f32 v213, v213, v213
v_lshlrev_b32 v213, 16, v213
v_rcp_f32 v206, v213
v_mfma_f32_16x16x32_bf16 v[56:59], v[60:63], v[48:51], v[56:59]
buffer_load_dwordx4 v4, s[32:35], s100 offen offset:2048 lds
v_lshrrev_b32 v214, 5, v1
s_waitcnt lgkmcnt(2)
v_mfma_f32_32x32x16_bf16 v[156:171], v[76:79], a[20:23], v[156:171]
ds_read_b128 a[24:27], v15 offset:28672
ds_read_b64_tr_b16 v[60:61], v25 offset:34816
ds_read_b64_tr_b16 v[62:63], v25 offset:35584
v_lshlrev_b32 v214, 4, v214
s_lshl_b32 s20, s44, 11
s_lshl_b32 s21, s45, 7
s_add_u32 s20, s20, s21
v_mfma_f32_32x32x16_bf16 v[172:187], v[80:83], a[20:23], v[172:187]
ds_read_b64_tr_b16 v[64:65], v26 offset:34816
ds_read_b64_tr_b16 v[66:67], v26 offset:35584
ds_read_b64_tr_b16 v[68:69], v27 offset:34816
ds_read_b64_tr_b16 v[70:71], v27 offset:35584
s_lshl_b32 s21, s16, 5
s_add_u32 s20, s20, s21
s_add_u32 s20, s20, 0xf00000
s_waitcnt lgkmcnt(7)
v_mfma_f32_32x32x16_bf16 v[188:203], v[84:87], a[20:23], v[188:203]
buffer_load_dwordx4 v5, s[32:35], s100 offen offset:3072 lds
s_mov_b32 exec_lo, 1
s_mov_b32 exec_hi, 1
buffer_store_dwordx4 v[204:207], v214, s[4:7], s20 offen sc1
s_mov_b64 exec, -1
v_mfma_f32_16x16x32_bf16 v[56:59], v[76:79], v[48:51], v[56:59]
s_mul_i32 s101, s66, 196608
s_add_u32 m0, s47, 114688
s_nop 0
buffer_load_dwordx4 v6, s[36:39], s101 offen offset:0 lds
s_waitcnt lgkmcnt(2)
v_mfma_f32_32x32x16_bf16 v[156:171], v[60:63], a[24:27], v[156:171]
ds_read_b128 a[28:31], v16 offset:28672
ds_read_b64_tr_b16 v[76:77], v25 offset:37888
ds_read_b64_tr_b16 v[78:79], v25 offset:38656
v_mfma_f32_32x32x16_bf16 v[172:187], v[64:67], a[24:27], v[172:187]
ds_read_b64_tr_b16 v[80:81], v26 offset:37888
ds_read_b64_tr_b16 v[82:83], v26 offset:38656
ds_read_b64_tr_b16 v[84:85], v27 offset:37888
ds_read_b64_tr_b16 v[86:87], v27 offset:38656
s_waitcnt lgkmcnt(7)
v_mfma_f32_32x32x16_bf16 v[188:203], v[68:71], a[24:27], v[188:203]
buffer_load_dwordx4 v7, s[36:39], s101 offen offset:1024 lds
v_mfma_f32_16x16x32_bf16 v[56:59], v[60:63], v[48:51], v[56:59]
buffer_load_dwordx4 v8, s[36:39], s101 offen offset:2048 lds
s_waitcnt lgkmcnt(0)
s_waitcnt vmcnt(15)
s_barrier
v_mfma_f32_32x32x16_bf16 v[156:171], v[76:79], a[28:31], v[156:171]
ds_read_b128 a[32:35], v17 offset:0
ds_read_b64_tr_b16 v[60:61], v28 offset:0
ds_read_b64_tr_b16 v[62:63], v28 offset:768
v_mfma_f32_32x32x16_bf16 v[172:187], v[80:83], a[28:31], v[172:187]
ds_read_b64_tr_b16 v[64:65], v29 offset:0
ds_read_b64_tr_b16 v[66:67], v29 offset:768
ds_read_b64_tr_b16 v[68:69], v30 offset:0
ds_read_b64_tr_b16 v[70:71], v30 offset:768
v_mfma_f32_32x32x16_bf16 v[188:203], v[84:87], a[28:31], v[188:203]
s_lshl_b32 s100, s67, 7
s_add_u32 m0, s46, 0
s_nop 0
buffer_load_dwordx4 v2, s[32:35], s100 offen offset:0 lds
v_mfma_f32_16x16x32_bf16 v[56:59], v[76:79], v[48:51], v[56:59]
buffer_load_dwordx4 v3, s[32:35], s100 offen offset:1024 lds
s_waitcnt lgkmcnt(2)
v_mfma_f32_32x32x16_bf16 v[156:171], v[60:63], a[32:35], v[156:171]
ds_read_b128 a[36:39], v18 offset:0
ds_read_b64_tr_b16 v[76:77], v28 offset:3072
ds_read_b64_tr_b16 v[78:79], v28 offset:3840
v_mfma_f32_32x32x16_bf16 v[172:187], v[64:67], a[32:35], v[172:187]
ds_read_b64_tr_b16 v[80:81], v29 offset:3072
ds_read_b64_tr_b16 v[82:83], v29 offset:3840
ds_read_b64_tr_b16 v[84:85], v30 offset:3072
ds_read_b64_tr_b16 v[86:87], v30 offset:3840
s_waitcnt lgkmcnt(7)
v_mfma_f32_32x32x16_bf16 v[188:203], v[68:71], a[32:35], v[188:203]
buffer_load_dwordx4 v4, s[32:35], s100 offen offset:2048 lds
v_mfma_f32_16x16x32_bf16 v[56:59], v[60:63], v[48:51], v[56:59]
buffer_load_dwordx4 v5, s[32:35], s100 offen offset:3072 lds
s_waitcnt lgkmcnt(2)
v_mfma_f32_32x32x16_bf16 v[156:171], v[76:79], a[36:39], v[156:171]
ds_read_b128 a[40:43], v19 offset:0
ds_read_b64_tr_b16 v[60:61], v28 offset:6144
ds_read_b64_tr_b16 v[62:63], v28 offset:6912
v_mfma_f32_32x32x16_bf16 v[172:187], v[80:83], a[36:39], v[172:187]
ds_read_b64_tr_b16 v[64:65], v29 offset:6144
ds_read_b64_tr_b16 v[66:67], v29 offset:6912
ds_read_b64_tr_b16 v[68:69], v30 offset:6144
ds_read_b64_tr_b16 v[70:71], v30 offset:6912
s_waitcnt lgkmcnt(7)
v_mfma_f32_32x32x16_bf16 v[188:203], v[84:87], a[36:39], v[188:203]
s_mul_i32 s101, s67, 196608
s_add_u32 m0, s47, 0
s_nop 0
buffer_load_dwordx4 v6, s[36:39], s101 offen offset:0 lds
v_mfma_f32_16x16x32_bf16 v[56:59], v[76:79], v[48:51], v[56:59]
buffer_load_dwordx4 v7, s[36:39], s101 offen offset:1024 lds
s_waitcnt lgkmcnt(2)
v_mfma_f32_32x32x16_bf16 v[156:171], v[60:63], a[40:43], v[156:171]
ds_read_b128 a[44:47], v20 offset:0
ds_read_b64_tr_b16 v[76:77], v28 offset:9216
ds_read_b64_tr_b16 v[78:79], v28 offset:9984
v_mfma_f32_32x32x16_bf16 v[172:187], v[64:67], a[40:43], v[172:187]
ds_read_b64_tr_b16 v[80:81], v29 offset:9216
ds_read_b64_tr_b16 v[82:83], v29 offset:9984
ds_read_b64_tr_b16 v[84:85], v30 offset:9216
ds_read_b64_tr_b16 v[86:87], v30 offset:9984
s_waitcnt lgkmcnt(7)
v_mfma_f32_32x32x16_bf16 v[188:203], v[68:71], a[40:43], v[188:203]
buffer_load_dwordx4 v8, s[36:39], s101 offen offset:2048 lds
v_mfma_f32_16x16x32_bf16 v[56:59], v[60:63], v[48:51], v[56:59]
s_lshl_b32 s100, s68, 7
s_add_u32 m0, s46, 28672
s_nop 0
buffer_load_dwordx4 v2, s[32:35], s100 offen offset:0 lds
s_waitcnt lgkmcnt(0)
s_waitcnt vmcnt(16)
s_barrier
v_mfma_f32_32x32x16_bf16 v[156:171], v[76:79], a[44:47], v[156:171]
ds_read_b128 a[48:51], v17 offset:28672
ds_read_b64_tr_b16 v[60:61], v28 offset:28672
ds_read_b64_tr_b16 v[62:63], v28 offset:29440
v_mfma_f32_32x32x16_bf16 v[172:187], v[80:83], a[44:47], v[172:187]
ds_read_b64_tr_b16 v[64:65], v29 offset:28672
ds_read_b64_tr_b16 v[66:67], v29 offset:29440
ds_read_b64_tr_b16 v[68:69], v30 offset:28672
ds_read_b64_tr_b16 v[70:71], v30 offset:29440
v_mfma_f32_32x32x16_bf16 v[188:203], v[84:87], a[44:47], v[188:203]
buffer_load_dwordx4 v3, s[32:35], s100 offen offset:1024 lds
v_mfma_f32_16x16x32_bf16 v[56:59], v[76:79], v[48:51], v[56:59]
buffer_load_dwordx4 v4, s[32:35], s100 offen offset:2048 lds
s_waitcnt lgkmcnt(2)
v_mfma_f32_32x32x16_bf16 v[156:171], v[60:63], a[48:51], v[156:171]
ds_read_b128 a[52:55], v18 offset:28672
ds_read_b64_tr_b16 v[76:77], v28 offset:31744
ds_read_b64_tr_b16 v[78:79], v28 offset:32512
v_mfma_f32_32x32x16_bf16 v[172:187], v[64:67], a[48:51], v[172:187]
ds_read_b64_tr_b16 v[80:81], v29 offset:31744
ds_read_b64_tr_b16 v[82:83], v29 offset:32512
ds_read_b64_tr_b16 v[84:85], v30 offset:31744
ds_read_b64_tr_b16 v[86:87], v30 offset:32512
s_waitcnt lgkmcnt(7)
v_mfma_f32_32x32x16_bf16 v[188:203], v[68:71], a[48:51], v[188:203]
buffer_load_dwordx4 v5, s[32:35], s100 offen offset:3072 lds
v_mfma_f32_16x16x32_bf16 v[56:59], v[60:63], v[48:51], v[56:59]
s_mul_i32 s101, s68, 196608
s_add_u32 m0, s47, 28672
s_nop 0
buffer_load_dwordx4 v6, s[36:39], s101 offen offset:0 lds
s_waitcnt lgkmcnt(2)
v_mfma_f32_32x32x16_bf16 v[156:171], v[76:79], a[52:55], v[156:171]
ds_read_b128 a[56:59], v19 offset:28672
ds_read_b64_tr_b16 v[60:61], v28 offset:34816
ds_read_b64_tr_b16 v[62:63], v28 offset:35584
v_mfma_f32_32x32x16_bf16 v[172:187], v[80:83], a[52:55], v[172:187]
ds_read_b64_tr_b16 v[64:65], v29 offset:34816
ds_read_b64_tr_b16 v[66:67], v29 offset:35584
ds_read_b64_tr_b16 v[68:69], v30 offset:34816
ds_read_b64_tr_b16 v[70:71], v30 offset:35584
s_waitcnt lgkmcnt(7)
v_mfma_f32_32x32x16_bf16 v[188:203], v[84:87], a[52:55], v[188:203]
buffer_load_dwordx4 v7, s[36:39], s101 offen offset:1024 lds
v_mfma_f32_16x16x32_bf16 v[56:59], v[76:79], v[48:51], v[56:59]
buffer_load_dwordx4 v8, s[36:39], s101 offen offset:2048 lds
s_waitcnt lgkmcnt(2)
v_mfma_f32_32x32x16_bf16 v[156:171], v[60:63], a[56:59], v[156:171]
ds_read_b128 a[60:63], v20 offset:28672
ds_read_b64_tr_b16 v[76:77], v28 offset:37888
ds_read_b64_tr_b16 v[78:79], v28 offset:38656
v_mfma_f32_32x32x16_bf16 v[172:187], v[64:67], a[56:59], v[172:187]
ds_read_b64_tr_b16 v[80:81], v29 offset:37888
ds_read_b64_tr_b16 v[82:83], v29 offset:38656
ds_read_b64_tr_b16 v[84:85], v30 offset:37888
ds_read_b64_tr_b16 v[86:87], v30 offset:38656
s_waitcnt lgkmcnt(7)
v_mfma_f32_32x32x16_bf16 v[188:203], v[68:71], a[56:59], v[188:203]
s_lshl_b32 s100, s69, 7
s_add_u32 m0, s46, 57344
s_nop 0
buffer_load_dwordx4 v2, s[32:35], s100 offen offset:0 lds
v_mfma_f32_16x16x32_bf16 v[56:59], v[60:63], v[48:51], v[56:59]
buffer_load_dwordx4 v3, s[32:35], s100 offen offset:1024 lds
s_waitcnt lgkmcnt(0)
s_waitcnt vmcnt(16)
s_barrier
v_mfma_f32_32x32x16_bf16 v[156:171], v[76:79], a[60:63], v[156:171]
ds_read_b128 a[64:67], v21 offset:0
ds_read_b64_tr_b16 v[60:61], v31 offset:0
ds_read_b64_tr_b16 v[62:63], v31 offset:768
v_mfma_f32_32x32x16_bf16 v[172:187], v[80:83], a[60:63], v[172:187]
ds_read_b64_tr_b16 v[64:65], v32 offset:0
ds_read_b64_tr_b16 v[66:67], v32 offset:768
ds_read_b64_tr_b16 v[68:69], v33 offset:0
ds_read_b64_tr_b16 v[70:71], v33 offset:768
v_mfma_f32_32x32x16_bf16 v[188:203], v[84:87], a[60:63], v[188:203]
buffer_load_dwordx4 v4, s[32:35], s100 offen offset:2048 lds
v_mfma_f32_16x16x32_bf16 v[56:59], v[76:79], v[48:51], v[56:59]
buffer_load_dwordx4 v5, s[32:35], s100 offen offset:3072 lds
s_waitcnt lgkmcnt(2)
v_mfma_f32_32x32x16_bf16 v[156:171], v[60:63], a[64:67], v[156:171]
ds_read_b128 a[68:71], v22 offset:0
ds_read_b64_tr_b16 v[76:77], v31 offset:3072
ds_read_b64_tr_b16 v[78:79], v31 offset:3840
v_mfma_f32_32x32x16_bf16 v[172:187], v[64:67], a[64:67], v[172:187]
ds_read_b64_tr_b16 v[80:81], v32 offset:3072
ds_read_b64_tr_b16 v[82:83], v32 offset:3840
ds_read_b64_tr_b16 v[84:85], v33 offset:3072
ds_read_b64_tr_b16 v[86:87], v33 offset:3840
s_waitcnt lgkmcnt(7)
v_mfma_f32_32x32x16_bf16 v[188:203], v[68:71], a[64:67], v[188:203]
s_mul_i32 s101, s69, 196608
s_add_u32 m0, s47, 57344
s_nop 0
buffer_load_dwordx4 v6, s[36:39], s101 offen offset:0 lds
v_mfma_f32_16x16x32_bf16 v[56:59], v[60:63], v[48:51], v[56:59]
buffer_load_dwordx4 v7, s[36:39], s101 offen offset:1024 lds
s_waitcnt lgkmcnt(2)
v_mfma_f32_32x32x16_bf16 v[156:171], v[76:79], a[68:71], v[156:171]
ds_read_b128 a[72:75], v23 offset:0
ds_read_b64_tr_b16 v[60:61], v31 offset:6144
ds_read_b64_tr_b16 v[62:63], v31 offset:6912
v_mfma_f32_32x32x16_bf16 v[172:187], v[80:83], a[68:71], v[172:187]
ds_read_b64_tr_b16 v[64:65], v32 offset:6144
ds_read_b64_tr_b16 v[66:67], v32 offset:6912
ds_read_b64_tr_b16 v[68:69], v33 offset:6144
ds_read_b64_tr_b16 v[70:71], v33 offset:6912
s_waitcnt lgkmcnt(7)
v_mfma_f32_32x32x16_bf16 v[188:203], v[84:87], a[68:71], v[188:203]
buffer_load_dwordx4 v8, s[36:39], s101 offen offset:2048 lds
v_mfma_f32_16x16x32_bf16 v[56:59], v[76:79], v[48:51], v[56:59]
s_mul_i32 s101, s62, 229376
s_add_u32 m0, s46, 86016
s_nop 0
buffer_load_dwordx4 v9, s[40:43], s101 offen offset:0 lds
s_waitcnt lgkmcnt(2)
v_mfma_f32_32x32x16_bf16 v[156:171], v[60:63], a[72:75], v[156:171]
ds_read_b128 a[76:79], v24 offset:0
ds_read_b64_tr_b16 v[76:77], v31 offset:9216
ds_read_b64_tr_b16 v[78:79], v31 offset:9984
v_mfma_f32_32x32x16_bf16 v[172:187], v[64:67], a[72:75], v[172:187]
ds_read_b64_tr_b16 v[80:81], v32 offset:9216
ds_read_b64_tr_b16 v[82:83], v32 offset:9984
ds_read_b64_tr_b16 v[84:85], v33 offset:9216
ds_read_b64_tr_b16 v[86:87], v33 offset:9984
s_waitcnt lgkmcnt(7)
v_mfma_f32_32x32x16_bf16 v[188:203], v[68:71], a[72:75], v[188:203]
buffer_load_dwordx4 v10, s[40:43], s101 offen offset:1024 lds
v_mfma_f32_16x16x32_bf16 v[56:59], v[60:63], v[48:51], v[56:59]
s_waitcnt lgkmcnt(0)
s_waitcnt vmcnt(16)
s_barrier
v_mfma_f32_32x32x16_bf16 v[156:171], v[76:79], a[76:79], v[156:171]
ds_read_b128 a[80:83], v13 offset:0
ds_read_b64_tr_b16 v[60:61], v25 offset:0
ds_read_b64_tr_b16 v[62:63], v25 offset:768
v_mfma_f32_32x32x16_bf16 v[172:187], v[80:83], a[76:79], v[172:187]
ds_read_b64_tr_b16 v[64:65], v26 offset:0
ds_read_b64_tr_b16 v[66:67], v26 offset:768
ds_read_b64_tr_b16 v[68:69], v27 offset:0
ds_read_b64_tr_b16 v[70:71], v27 offset:768
v_mfma_f32_32x32x16_bf16 v[188:203], v[84:87], a[76:79], v[188:203]
buffer_load_dwordx4 v11, s[40:43], s101 offen offset:2048 lds
v_mfma_f32_16x16x32_bf16 v[56:59], v[76:79], v[48:51], v[56:59]
s_waitcnt lgkmcnt(2)
v_mfma_f32_32x32x16_bf16 v[156:171], v[60:63], a[80:83], v[156:171]
ds_read_b128 a[84:87], v14 offset:0
ds_read_b64_tr_b16 v[76:77], v25 offset:3072
ds_read_b64_tr_b16 v[78:79], v25 offset:3840
v_mfma_f32_32x32x16_bf16 v[172:187], v[64:67], a[80:83], v[172:187]
ds_read_b64_tr_b16 v[80:81], v26 offset:3072
ds_read_b64_tr_b16 v[82:83], v26 offset:3840
ds_read_b64_tr_b16 v[84:85], v27 offset:3072
ds_read_b64_tr_b16 v[86:87], v27 offset:3840
s_waitcnt lgkmcnt(7)
v_mfma_f32_32x32x16_bf16 v[188:203], v[68:71], a[80:83], v[188:203]
buffer_load_dwordx4 v12, s[40:43], s101 offen offset:3072 lds
v_mfma_f32_16x16x32_bf16 v[56:59], v[60:63], v[48:51], v[56:59]
s_waitcnt lgkmcnt(2)
v_mfma_f32_32x32x16_bf16 v[156:171], v[76:79], a[84:87], v[156:171]
ds_read_b128 a[88:91], v15 offset:0
ds_read_b64_tr_b16 v[60:61], v25 offset:6144
ds_read_b64_tr_b16 v[62:63], v25 offset:6912
v_mfma_f32_32x32x16_bf16 v[172:187], v[80:83], a[84:87], v[172:187]
ds_read_b64_tr_b16 v[64:65], v26 offset:6144
ds_read_b64_tr_b16 v[66:67], v26 offset:6912
ds_read_b64_tr_b16 v[68:69], v27 offset:6144
ds_read_b64_tr_b16 v[70:71], v27 offset:6912
s_waitcnt lgkmcnt(7)
v_mfma_f32_32x32x16_bf16 v[188:203], v[84:87], a[84:87], v[188:203]
s_mul_i32 s101, s63, 229376
s_add_u32 m0, s46, 114688
s_nop 0
buffer_load_dwordx4 v9, s[40:43], s101 offen offset:0 lds
v_mfma_f32_16x16x32_bf16 v[56:59], v[76:79], v[48:51], v[56:59]
s_waitcnt lgkmcnt(2)
v_mfma_f32_32x32x16_bf16 v[156:171], v[60:63], a[88:91], v[156:171]
ds_read_b128 a[92:95], v16 offset:0
ds_read_b64_tr_b16 v[76:77], v25 offset:9216
ds_read_b64_tr_b16 v[78:79], v25 offset:9984
v_mfma_f32_32x32x16_bf16 v[172:187], v[64:67], a[88:91], v[172:187]
ds_read_b64_tr_b16 v[80:81], v26 offset:9216
ds_read_b64_tr_b16 v[82:83], v26 offset:9984
ds_read_b64_tr_b16 v[84:85], v27 offset:9216
ds_read_b64_tr_b16 v[86:87], v27 offset:9984
s_waitcnt lgkmcnt(7)
v_mfma_f32_32x32x16_bf16 v[188:203], v[68:71], a[88:91], v[188:203]
buffer_load_dwordx4 v10, s[40:43], s101 offen offset:1024 lds
v_mfma_f32_16x16x32_bf16 v[56:59], v[60:63], v[48:51], v[56:59]
s_waitcnt lgkmcnt(0)
s_waitcnt vmcnt(13)
s_barrier
v_mfma_f32_32x32x16_bf16 v[156:171], v[76:79], a[92:95], v[156:171]
ds_read_b128 a[96:99], v13 offset:28672
ds_read_b64_tr_b16 v[60:61], v25 offset:28672
ds_read_b64_tr_b16 v[62:63], v25 offset:29440
v_mfma_f32_32x32x16_bf16 v[172:187], v[80:83], a[92:95], v[172:187]
ds_read_b64_tr_b16 v[64:65], v26 offset:28672
ds_read_b64_tr_b16 v[66:67], v26 offset:29440
ds_read_b64_tr_b16 v[68:69], v27 offset:28672
ds_read_b64_tr_b16 v[70:71], v27 offset:29440
v_mfma_f32_32x32x16_bf16 v[188:203], v[84:87], a[92:95], v[188:203]
buffer_load_dwordx4 v11, s[40:43], s101 offen offset:2048 lds
s_lshl_b32 s31, s51, 9
s_add_u32 s31, s31, 0xf00000
buffer_load_dwordx4 v[216:219], v246, s[4:7], s31 offen sc1
v_mfma_f32_16x16x32_bf16 v[56:59], v[76:79], v[48:51], v[56:59]
s_waitcnt lgkmcnt(2)
v_mfma_f32_32x32x16_bf16 v[156:171], v[60:63], a[96:99], v[156:171]
ds_read_b128 a[100:103], v14 offset:28672
ds_read_b64_tr_b16 v[76:77], v25 offset:31744
ds_read_b64_tr_b16 v[78:79], v25 offset:32512
v_mfma_f32_32x32x16_bf16 v[172:187], v[64:67], a[96:99], v[172:187]
ds_read_b64_tr_b16 v[80:81], v26 offset:31744
ds_read_b64_tr_b16 v[82:83], v26 offset:32512
ds_read_b64_tr_b16 v[84:85], v27 offset:31744
ds_read_b64_tr_b16 v[86:87], v27 offset:32512
s_waitcnt lgkmcnt(7)
v_mfma_f32_32x32x16_bf16 v[188:203], v[68:71], a[96:99], v[188:203]
buffer_load_dwordx4 v12, s[40:43], s101 offen offset:3072 lds
v_mfma_f32_16x16x32_bf16 v[56:59], v[60:63], v[48:51], v[56:59]
s_waitcnt lgkmcnt(2)
v_mfma_f32_32x32x16_bf16 v[156:171], v[76:79], a[100:103], v[156:171]
ds_read_b128 a[104:107], v15 offset:28672
ds_read_b64_tr_b16 v[60:61], v25 offset:34816
ds_read_b64_tr_b16 v[62:63], v25 offset:35584
v_mfma_f32_32x32x16_bf16 v[172:187], v[80:83], a[100:103], v[172:187]
ds_read_b64_tr_b16 v[64:65], v26 offset:34816
ds_read_b64_tr_b16 v[66:67], v26 offset:35584
ds_read_b64_tr_b16 v[68:69], v27 offset:34816
ds_read_b64_tr_b16 v[70:71], v27 offset:35584
s_waitcnt lgkmcnt(7)
v_mfma_f32_32x32x16_bf16 v[188:203], v[84:87], a[100:103], v[188:203]
s_mul_i32 s101, s64, 229376
s_add_u32 m0, s46, 0
s_nop 0
buffer_load_dwordx4 v9, s[40:43], s101 offen offset:0 lds
v_mfma_f32_16x16x32_bf16 v[56:59], v[76:79], v[48:51], v[56:59]
s_waitcnt lgkmcnt(2)
v_mfma_f32_32x32x16_bf16 v[156:171], v[60:63], a[104:107], v[156:171]
ds_read_b128 a[108:111], v16 offset:28672
ds_read_b64_tr_b16 v[76:77], v25 offset:37888
ds_read_b64_tr_b16 v[78:79], v25 offset:38656
v_mfma_f32_32x32x16_bf16 v[172:187], v[64:67], a[104:107], v[172:187]
ds_read_b64_tr_b16 v[80:81], v26 offset:37888
ds_read_b64_tr_b16 v[82:83], v26 offset:38656
ds_read_b64_tr_b16 v[84:85], v27 offset:37888
ds_read_b64_tr_b16 v[86:87], v27 offset:38656
s_waitcnt lgkmcnt(7)
v_mfma_f32_32x32x16_bf16 v[188:203], v[68:71], a[104:107], v[188:203]
buffer_load_dwordx4 v10, s[40:43], s101 offen offset:1024 lds
v_mfma_f32_16x16x32_bf16 v[56:59], v[60:63], v[48:51], v[56:59]
s_waitcnt lgkmcnt(0)
s_waitcnt vmcnt(11)
s_barrier
v_mfma_f32_32x32x16_bf16 v[156:171], v[76:79], a[108:111], v[156:171]
ds_read_b128 a[112:115], v17 offset:0
ds_read_b64_tr_b16 v[60:61], v28 offset:0
ds_read_b64_tr_b16 v[62:63], v28 offset:768
v_mfma_f32_32x32x16_bf16 v[172:187], v[80:83], a[108:111], v[172:187]
ds_read_b64_tr_b16 v[64:65], v29 offset:0
ds_read_b64_tr_b16 v[66:67], v29 offset:768
ds_read_b64_tr_b16 v[68:69], v30 offset:0
ds_read_b64_tr_b16 v[70:71], v30 offset:768
v_mfma_f32_32x32x16_bf16 v[188:203], v[84:87], a[108:111], v[188:203]
buffer_load_dwordx4 v11, s[40:43], s101 offen offset:2048 lds
v_mfma_f32_16x16x32_bf16 v[56:59], v[76:79], v[48:51], v[56:59]
s_waitcnt lgkmcnt(2)
v_mfma_f32_32x32x16_bf16 v[156:171], v[60:63], a[112:115], v[156:171]
ds_read_b128 a[116:119], v18 offset:0
ds_read_b64_tr_b16 v[76:77], v28 offset:3072
ds_read_b64_tr_b16 v[78:79], v28 offset:3840
v_mfma_f32_32x32x16_bf16 v[172:187], v[64:67], a[112:115], v[172:187]
ds_read_b64_tr_b16 v[80:81], v29 offset:3072
ds_read_b64_tr_b16 v[82:83], v29 offset:3840
ds_read_b64_tr_b16 v[84:85], v30 offset:3072
ds_read_b64_tr_b16 v[86:87], v30 offset:3840
s_waitcnt lgkmcnt(7)
v_mfma_f32_32x32x16_bf16 v[188:203], v[68:71], a[112:115], v[188:203]
buffer_load_dwordx4 v12, s[40:43], s101 offen offset:3072 lds
v_mfma_f32_16x16x32_bf16 v[56:59], v[60:63], v[48:51], v[56:59]
s_waitcnt lgkmcnt(2)
v_mfma_f32_32x32x16_bf16 v[156:171], v[76:79], a[116:119], v[156:171]
ds_read_b128 a[120:123], v19 offset:0
ds_read_b64_tr_b16 v[60:61], v28 offset:6144
ds_read_b64_tr_b16 v[62:63], v28 offset:6912
v_mfma_f32_32x32x16_bf16 v[172:187], v[80:83], a[116:119], v[172:187]
ds_read_b64_tr_b16 v[64:65], v29 offset:6144
ds_read_b64_tr_b16 v[66:67], v29 offset:6912
ds_read_b64_tr_b16 v[68:69], v30 offset:6144
ds_read_b64_tr_b16 v[70:71], v30 offset:6912
s_waitcnt lgkmcnt(7)
v_mfma_f32_32x32x16_bf16 v[188:203], v[84:87], a[116:119], v[188:203]
s_mul_i32 s101, s65, 229376
s_add_u32 m0, s46, 28672
s_nop 0
buffer_load_dwordx4 v9, s[40:43], s101 offen offset:0 lds
v_mfma_f32_16x16x32_bf16 v[56:59], v[76:79], v[48:51], v[56:59]
s_waitcnt lgkmcnt(2)
v_mfma_f32_32x32x16_bf16 v[156:171], v[60:63], a[120:123], v[156:171]
ds_read_b128 a[124:127], v20 offset:0
ds_read_b64_tr_b16 v[76:77], v28 offset:9216
ds_read_b64_tr_b16 v[78:79], v28 offset:9984
v_mfma_f32_32x32x16_bf16 v[172:187], v[64:67], a[120:123], v[172:187]
ds_read_b64_tr_b16 v[80:81], v29 offset:9216
ds_read_b64_tr_b16 v[82:83], v29 offset:9984
ds_read_b64_tr_b16 v[84:85], v30 offset:9216
ds_read_b64_tr_b16 v[86:87], v30 offset:9984
s_waitcnt lgkmcnt(7)
v_mfma_f32_32x32x16_bf16 v[188:203], v[68:71], a[120:123], v[188:203]
buffer_load_dwordx4 v10, s[40:43], s101 offen offset:1024 lds
v_mfma_f32_16x16x32_bf16 v[56:59], v[60:63], v[48:51], v[56:59]
s_waitcnt lgkmcnt(2)
v_mfma_f32_32x32x16_bf16 v[156:171], v[76:79], a[124:127], v[156:171]
v_mfma_f32_32x32x16_bf16 v[172:187], v[80:83], a[124:127], v[172:187]
s_waitcnt lgkmcnt(0)
v_mfma_f32_32x32x16_bf16 v[188:203], v[84:87], a[124:127], v[188:203]
buffer_load_dwordx4 v11, s[40:43], s101 offen offset:2048 lds
v_mfma_f32_16x16x32_bf16 v[56:59], v[76:79], v[48:51], v[56:59]
s_lshl_b32 s20, s54, 7
v_add_u32 v220, s20, v243
s_nop 5
ds_write_b128 v220, v[56:59]
s_waitcnt vmcnt(8)
s_mov_b32 s21, 20000
sl_2:
v_cmp_ne_u32 vcc, s17, v217
v_cmp_ne_u32 s[22:23], s17, v219
s_or_b64 s[22:23], s[22:23], vcc
s_cbranch_scc0 sok_1
s_sub_u32 s21, s21, 1
s_cmp_eq_u32 s21, 0
s_cbranch_scc1 sok_1
buffer_load_dwordx4 v[216:219], v246, s[4:7], s31 offen sc1
s_waitcnt vmcnt(0)
s_branch sl_2
sok_1:
v_mov_b32 v236, v216
v_mov_b32 v237, v216
v_mov_b32 v240, v218
s_waitcnt lgkmcnt(0)
s_barrier
s_lshl_b32 s20, s54, 7
v_add_u32 v220, s20, v244
ds_read_b128 v[92:95], v220 offset:0
ds_read_b128 v[96:99], v220 offset:32
ds_read_b128 v[100:103], v220 offset:64
ds_read_b128 v[104:107], v220 offset:96
s_lshl_b32 s20, s55, 7
v_add_u32 v220, s20, v244
ds_read_b128 v[108:111], v220 offset:0
ds_read_b128 v[112:115], v220 offset:32
ds_read_b128 v[116:119], v220 offset:64
ds_read_b128 v[120:123], v220 offset:96
s_lshl_b32 s20, s56, 7
v_add_u32 v220, s20, v244
ds_read_b128 v[124:127], v220 offset:0
ds_read_b128 v[128:131], v220 offset:32
ds_read_b128 v[132:135], v220 offset:64
ds_read_b128 v[136:139], v220 offset:96
s_mul_i32 s20, s45, 3
s_add_u32 s20, s20, s54
s_and_b32 s21, s20, 15
s_lshr_b32 s20, s20, 4
s_lshl_b32 s22, s20, 21
s_lshl_b32 s21, s21, 17
s_add_u32 s22, s22, s21
s_lshl_b32 s21, s51, 10
s_add_u32 s22, s22, s21
s_add_u32 s23, s22, 65536
s_cmp_eq_u32 s20, 0
s_cselect_b32 s24, 0x3eb8aa3b, 1.0
s_cmp_eq_u32 s20, 2
s_cselect_b64 s[26:27], -1, 0
v_mul_f32 v238, s24, v240
v_mov_b32 v239, v238
v_cndmask_b32 v222, v241, v242, s[26:27]
s_waitcnt lgkmcnt(8)
v_pk_fma_f32 v[156:157], v[236:237], v[92:93], v[156:157]
v_pk_fma_f32 v[158:159], v[236:237], v[94:95], v[158:159]
v_pk_fma_f32 v[160:161], v[236:237], v[96:97], v[160:161]
v_pk_fma_f32 v[162:163], v[236:237], v[98:99], v[162:163]
v_pk_fma_f32 v[164:165], v[236:237], v[100:101], v[164:165]
v_pk_fma_f32 v[166:167], v[236:237], v[102:103], v[166:167]
v_pk_fma_f32 v[168:169], v[236:237], v[104:105], v[168:169]
v_pk_fma_f32 v[170:171], v[236:237], v[106:107], v[170:171]
v_pk_mul_f32 v[156:157], v[238:239], v[156:157]
v_pk_mul_f32 v[158:159], v[238:239], v[158:159]
v_pk_mul_f32 v[160:161], v[238:239], v[160:161]
v_pk_mul_f32 v[162:163], v[238:239], v[162:163]
v_pk_mul_f32 v[164:165], v[238:239], v[164:165]
v_pk_mul_f32 v[166:167], v[238:239], v[166:167]
v_pk_mul_f32 v[168:169], v[238:239], v[168:169]
v_pk_mul_f32 v[170:171], v[238:239], v[170:171]
v_cvt_pk_bf16_f32 v92, v156, v157
v_cvt_pk_bf16_f32 v93, v158, v159
v_cvt_pk_bf16_f32 v94, v160, v161
v_cvt_pk_bf16_f32 v95, v162, v163
v_cvt_pk_bf16_f32 v96, v164, v165
v_cvt_pk_bf16_f32 v97, v166, v167
v_cvt_pk_bf16_f32 v98, v168, v169
v_cvt_pk_bf16_f32 v99, v170, v171
buffer_store_dwordx4 v[92:95], v222, s[4:7], s22 offen sc1
buffer_store_dwordx4 v[96:99], v222, s[4:7], s23 offen sc1
s_mul_i32 s20, s45, 3
s_add_u32 s20, s20, s55
s_and_b32 s21, s20, 15
s_lshr_b32 s20, s20, 4
s_lshl_b32 s22, s20, 21
s_lshl_b32 s21, s21, 17
s_add_u32 s22, s22, s21
s_lshl_b32 s21, s51, 10
s_add_u32 s22, s22, s21
s_add_u32 s23, s22, 65536
s_cmp_eq_u32 s20, 0
s_cselect_b32 s24, 0x3eb8aa3b, 1.0
s_cmp_eq_u32 s20, 2
s_cselect_b64 s[26:27], -1, 0
v_mul_f32 v238, s24, v240
v_mov_b32 v239, v238
v_cndmask_b32 v222, v241, v242, s[26:27]
s_waitcnt lgkmcnt(4)
v_pk_fma_f32 v[172:173], v[236:237], v[108:109], v[172:173]
v_pk_fma_f32 v[174:175], v[236:237], v[110:111], v[174:175]
v_pk_fma_f32 v[176:177], v[236:237], v[112:113], v[176:177]
v_pk_fma_f32 v[178:179], v[236:237], v[114:115], v[178:179]
v_pk_fma_f32 v[180:181], v[236:237], v[116:117], v[180:181]
v_pk_fma_f32 v[182:183], v[236:237], v[118:119], v[182:183]
v_pk_fma_f32 v[184:185], v[236:237], v[120:121], v[184:185]
v_pk_fma_f32 v[186:187], v[236:237], v[122:123], v[186:187]
v_pk_mul_f32 v[172:173], v[238:239], v[172:173]
v_pk_mul_f32 v[174:175], v[238:239], v[174:175]
v_pk_mul_f32 v[176:177], v[238:239], v[176:177]
v_pk_mul_f32 v[178:179], v[238:239], v[178:179]
v_pk_mul_f32 v[180:181], v[238:239], v[180:181]
v_pk_mul_f32 v[182:183], v[238:239], v[182:183]
v_pk_mul_f32 v[184:185], v[238:239], v[184:185]
v_pk_mul_f32 v[186:187], v[238:239], v[186:187]
v_cvt_pk_bf16_f32 v108, v172, v173
v_cvt_pk_bf16_f32 v109, v174, v175
v_cvt_pk_bf16_f32 v110, v176, v177
v_cvt_pk_bf16_f32 v111, v178, v179
v_cvt_pk_bf16_f32 v112, v180, v181
v_cvt_pk_bf16_f32 v113, v182, v183
v_cvt_pk_bf16_f32 v114, v184, v185
v_cvt_pk_bf16_f32 v115, v186, v187
buffer_store_dwordx4 v[108:111], v222, s[4:7], s22 offen sc1
buffer_store_dwordx4 v[112:115], v222, s[4:7], s23 offen sc1
s_mul_i32 s20, s45, 3
s_add_u32 s20, s20, s56
s_and_b32 s21, s20, 15
s_lshr_b32 s20, s20, 4
s_lshl_b32 s22, s20, 21
s_lshl_b32 s21, s21, 17
s_add_u32 s22, s22, s21
s_lshl_b32 s21, s51, 10
s_add_u32 s22, s22, s21
s_add_u32 s23, s22, 65536
s_cmp_eq_u32 s20, 0
s_cselect_b32 s24, 0x3eb8aa3b, 1.0
s_cmp_eq_u32 s20, 2
s_cselect_b64 s[26:27], -1, 0
v_mul_f32 v238, s24, v240
v_mov_b32 v239, v238
v_cndmask_b32 v222, v241, v242, s[26:27]
s_waitcnt lgkmcnt(0)
v_pk_fma_f32 v[188:189], v[236:237], v[124:125], v[188:189]
v_pk_fma_f32 v[190:191], v[236:237], v[126:127], v[190:191]
v_pk_fma_f32 v[192:193], v[236:237], v[128:129], v[192:193]
v_pk_fma_f32 v[194:195], v[236:237], v[130:131], v[194:195]
v_pk_fma_f32 v[196:197], v[236:237], v[132:133], v[196:197]
v_pk_fma_f32 v[198:199], v[236:237], v[134:135], v[198:199]
v_pk_fma_f32 v[200:201], v[236:237], v[136:137], v[200:201]
v_pk_fma_f32 v[202:203], v[236:237], v[138:139], v[202:203]
v_pk_mul_f32 v[188:189], v[238:239], v[188:189]
v_pk_mul_f32 v[190:191], v[238:239], v[190:191]
v_pk_mul_f32 v[192:193], v[238:239], v[192:193]
v_pk_mul_f32 v[194:195], v[238:239], v[194:195]
v_pk_mul_f32 v[196:197], v[238:239], v[196:197]
v_pk_mul_f32 v[198:199], v[238:239], v[198:199]
v_pk_mul_f32 v[200:201], v[238:239], v[200:201]
v_pk_mul_f32 v[202:203], v[238:239], v[202:203]
v_cvt_pk_bf16_f32 v124, v188, v189
v_cvt_pk_bf16_f32 v125, v190, v191
v_cvt_pk_bf16_f32 v126, v192, v193
v_cvt_pk_bf16_f32 v127, v194, v195
v_cvt_pk_bf16_f32 v128, v196, v197
v_cvt_pk_bf16_f32 v129, v198, v199
v_cvt_pk_bf16_f32 v130, v200, v201
v_cvt_pk_bf16_f32 v131, v202, v203
buffer_store_dwordx4 v[124:127], v222, s[4:7], s22 offen sc1
buffer_store_dwordx4 v[128:131], v222, s[4:7], s23 offen sc1
s_barrier
ds_read_b64_tr_b16 v[60:61], v38 offset:28672
ds_read_b64_tr_b16 v[62:63], v38 offset:29696
ds_read_b64_tr_b16 v[64:65], v39 offset:28672
ds_read_b64_tr_b16 v[66:67], v39 offset:29696
ds_read_b64_tr_b16 v[68:69], v40 offset:28672
ds_read_b64_tr_b16 v[70:71], v40 offset:29696
ds_read_b64_tr_b16 v[72:73], v41 offset:28672
ds_read_b64_tr_b16 v[74:75], v41 offset:29696
s_waitcnt lgkmcnt(4)
v_mfma_f32_32x32x16_bf16 v[92:107], v[60:63], a[0:3], 0
ds_read_b64_tr_b16 v[76:77], v38 offset:32768
ds_read_b64_tr_b16 v[78:79], v38 offset:33792
ds_read_b64_tr_b16 v[80:81], v39 offset:32768
ds_read_b64_tr_b16 v[82:83], v39 offset:33792
v_mfma_f32_32x32x16_bf16 v[108:123], v[64:67], a[0:3], 0
ds_read_b64_tr_b16 v[84:85], v40 offset:32768
ds_read_b64_tr_b16 v[86:87], v40 offset:33792
s_waitcnt lgkmcnt(6)
v_mfma_f32_32x32x16_bf16 v[124:139], v[68:71], a[0:3], 0
ds_read_b64_tr_b16 v[88:89], v41 offset:32768
ds_read_b64_tr_b16 v[90:91], v41 offset:33792
v_mfma_f32_32x32x16_bf16 v[140:155], v[72:75], a[0:3], 0
buffer_load_dwordx4 v12, s[40:43], s101 offen offset:3072 lds
v_mfma_f32_16x16x32_bf16 v[56:59], v[60:63], v[48:51], 0
s_waitcnt lgkmcnt(4)
v_mfma_f32_32x32x16_bf16 v[92:107], v[76:79], a[4:7], v[92:107]
ds_read_b64_tr_b16 v[60:61], v38 offset:36864
ds_read_b64_tr_b16 v[62:63], v38 offset:37888
ds_read_b64_tr_b16 v[64:65], v39 offset:36864
ds_read_b64_tr_b16 v[66:67], v39 offset:37888
v_mfma_f32_32x32x16_bf16 v[108:123], v[80:83], a[4:7], v[108:123]
ds_read_b64_tr_b16 v[68:69], v40 offset:36864
ds_read_b64_tr_b16 v[70:71], v40 offset:37888
s_waitcnt lgkmcnt(6)
v_mfma_f32_32x32x16_bf16 v[124:139], v[84:87], a[4:7], v[124:139]
ds_read_b64_tr_b16 v[72:73], v41 offset:36864
ds_read_b64_tr_b16 v[74:75], v41 offset:37888
v_mfma_f32_32x32x16_bf16 v[140:155], v[88:91], a[4:7], v[140:155]
s_mul_i32 s101, s66, 229376
s_add_u32 m0, s46, 57344
s_nop 0
buffer_load_dwordx4 v9, s[40:43], s101 offen offset:0 lds
v_mfma_f32_16x16x32_bf16 v[56:59], v[76:79], v[48:51], v[56:59]
s_waitcnt lgkmcnt(4)
v_mfma_f32_32x32x16_bf16 v[92:107], v[60:63], a[8:11], v[92:107]
ds_read_b64_tr_b16 v[76:77], v38 offset:40960
ds_read_b64_tr_b16 v[78:79], v38 offset:41984
ds_read_b64_tr_b16 v[80:81], v39 offset:40960
ds_read_b64_tr_b16 v[82:83], v39 offset:41984
v_mfma_f32_32x32x16_bf16 v[108:123], v[64:67], a[8:11], v[108:123]
ds_read_b64_tr_b16 v[84:85], v40 offset:40960
ds_read_b64_tr_b16 v[86:87], v40 offset:41984
s_waitcnt lgkmcnt(6)
v_mfma_f32_32x32x16_bf16 v[124:139], v[68:71], a[8:11], v[124:139]
ds_read_b64_tr_b16 v[88:89], v41 offset:40960
ds_read_b64_tr_b16 v[90:91], v41 offset:41984
v_mfma_f32_32x32x16_bf16 v[140:155], v[72:75], a[8:11], v[140:155]
buffer_load_dwordx4 v10, s[40:43], s101 offen offset:1024 lds
v_mfma_f32_16x16x32_bf16 v[56:59], v[60:63], v[48:51], v[56:59]
s_waitcnt lgkmcnt(0)
s_waitcnt vmcnt(16)
s_barrier
v_mfma_f32_32x32x16_bf16 v[92:107], v[76:79], a[12:15], v[92:107]
ds_read_b64_tr_b16 v[60:61], v42 offset:0
ds_read_b64_tr_b16 v[62:63], v42 offset:1024
ds_read_b64_tr_b16 v[64:65], v43 offset:0
ds_read_b64_tr_b16 v[66:67], v43 offset:1024
v_mfma_f32_32x32x16_bf16 v[108:123], v[80:83], a[12:15], v[108:123]
ds_read_b64_tr_b16 v[68:69], v44 offset:0
ds_read_b64_tr_b16 v[70:71], v44 offset:1024
v_mfma_f32_32x32x16_bf16 v[124:139], v[84:87], a[12:15], v[124:139]
ds_read_b64_tr_b16 v[72:73], v45 offset:0
ds_read_b64_tr_b16 v[74:75], v45 offset:1024
s_mov_b32 s24, s10
s_mov_b32 s25, s11
s_mov_b32 s26, 0x1c0000
s_mov_b32 s27, 0x20000
s_lshl_b32 s21, s2, 2
v_mfma_f32_32x32x16_bf16 v[140:155], v[88:91], a[12:15], v[140:155]
buffer_load_dwordx4 v11, s[40:43], s101 offen offset:2048 lds
s_add_u32 s21, s21, s16
s_mul_i32 s20, s21, 1792
v_lshlrev_b32 v223, 7, v1
v_mov_b32 v224, 0x7ff00000
s_mov_b32 s22, 14
v_cmp_gt_u32 s[22:23], s22, v1
v_mfma_f32_16x16x32_bf16 v[56:59], v[76:79], v[48:51], v[56:59]
s_nop 0
v_cndmask_b32 v223, v224, v223, s[22:23]
buffer_load_dword v245, v223, s[24:27], s20 offen
s_waitcnt lgkmcnt(4)
v_mfma_f32_32x32x16_bf16 v[92:107], v[60:63], a[16:19], v[92:107]
ds_read_b64_tr_b16 v[76:77], v42 offset:4096
ds_read_b64_tr_b16 v[78:79], v42 offset:5120
ds_read_b64_tr_b16 v[80:81], v43 offset:4096
ds_read_b64_tr_b16 v[82:83], v43 offset:5120
s_mov_b32 s24, s12
s_mov_b32 s25, s13
s_mov_b32 s26, 0x80000
v_mfma_f32_32x32x16_bf16 v[108:123], v[64:67], a[16:19], v[108:123]
ds_read_b64_tr_b16 v[84:85], v44 offset:4096
ds_read_b64_tr_b16 v[86:87], v44 offset:5120
s_mov_b32 s27, 0x20000
s_lshl_b32 s21, s2, 2
s_add_u32 s21, s21, s16
s_mul_i32 s20, s21, 512
v_lshlrev_b32 v223, 7, v1
s_waitcnt lgkmcnt(6)
v_mfma_f32_32x32x16_bf16 v[124:139], v[68:71], a[16:19], v[124:139]
ds_read_b64_tr_b16 v[88:89], v45 offset:4096
ds_read_b64_tr_b16 v[90:91], v45 offset:5120
v_mov_b32 v224, 0x7ff00000
s_mov_b32 s22, 4
v_cmp_gt_u32 s[22:23], s22, v1
s_nop 1
v_cndmask_b32 v223, v224, v223, s[22:23]
buffer_load_dword v245, v223, s[24:27], s20 offen
v_mfma_f32_32x32x16_bf16 v[140:155], v[72:75], a[16:19], v[140:155]
buffer_load_dwordx4 v12, s[40:43], s101 offen offset:3072 lds
v_mov_b32 v172, v56
v_mov_b32 v173, s17
v_mov_b32 v174, v57
v_mov_b32 v175, s17
v_mov_b32 v176, v58
v_mov_b32 v177, s17
s_waitcnt lgkmcnt(4)
v_mfma_f32_32x32x16_bf16 v[92:107], v[76:79], a[20:23], v[92:107]
ds_read_b64_tr_b16 v[60:61], v42 offset:8192
ds_read_b64_tr_b16 v[62:63], v42 offset:9216
ds_read_b64_tr_b16 v[64:65], v43 offset:8192
ds_read_b64_tr_b16 v[66:67], v43 offset:9216
v_mov_b32 v178, v59
v_mov_b32 v179, s17
v_and_b32 v180, 1, v1
v_mfma_f32_32x32x16_bf16 v[108:123], v[80:83], a[20:23], v[108:123]
ds_read_b64_tr_b16 v[68:69], v44 offset:8192
ds_read_b64_tr_b16 v[70:71], v44 offset:9216
v_lshlrev_b32 v180, 7, v180
v_lshrrev_b32 v181, 4, v1
v_lshlrev_b32 v181, 5, v181
v_add_u32 v180, v180, v181
s_lshl_b32 s20, s45, 4
s_waitcnt lgkmcnt(6)
v_mfma_f32_32x32x16_bf16 v[124:139], v[84:87], a[20:23], v[124:139]
ds_read_b64_tr_b16 v[72:73], v45 offset:8192
ds_read_b64_tr_b16 v[74:75], v45 offset:9216
s_add_u32 s20, s20, s44
s_lshl_b32 s20, s20, 11
s_lshl_b32 s21, s58, 8
s_add_u32 s20, s20, s21
s_add_u32 s20, s20, 0x1000000
v_mfma_f32_32x32x16_bf16 v[140:155], v[88:91], a[20:23], v[140:155]
s_mul_i32 s101, s67, 229376
s_add_u32 m0, s46, 86016
s_nop 0
buffer_load_dwordx4 v9, s[40:43], s101 offen offset:0 lds
s_waitcnt lgkmcnt(4)
v_mfma_f32_32x32x16_bf16 v[92:107], v[60:63], a[24:27], v[92:107]
ds_read_b64_tr_b16 v[76:77], v42 offset:12288
ds_read_b64_tr_b16 v[78:79], v42 offset:13312
ds_read_b64_tr_b16 v[80:81], v43 offset:12288
ds_read_b64_tr_b16 v[82:83], v43 offset:13312
v_mfma_f32_32x32x16_bf16 v[108:123], v[64:67], a[24:27], v[108:123]
ds_read_b64_tr_b16 v[84:85], v44 offset:12288
ds_read_b64_tr_b16 v[86:87], v44 offset:13312
s_mov_b32 exec_lo, 0x00030003
s_mov_b32 exec_hi, 0x00030003
buffer_store_dwordx4 v[172:175], v180, s[4:7], s20 offen sc1
buffer_store_dwordx4 v[176:179], v180, s[4:7], s20 offen offset:16 sc1
s_mov_b64 exec, -1
s_waitcnt lgkmcnt(6)
v_mfma_f32_32x32x16_bf16 v[124:139], v[68:71], a[24:27], v[124:139]
ds_read_b64_tr_b16 v[88:89], v45 offset:12288
ds_read_b64_tr_b16 v[90:91], v45 offset:13312
v_mfma_f32_32x32x16_bf16 v[140:155], v[72:75], a[24:27], v[140:155]
buffer_load_dwordx4 v10, s[40:43], s101 offen offset:1024 lds
s_waitcnt lgkmcnt(0)
s_waitcnt vmcnt(20)
s_barrier
v_mfma_f32_32x32x16_bf16 v[92:107], v[76:79], a[28:31], v[92:107]
ds_read_b64_tr_b16 v[60:61], v34 offset:0
ds_read_b64_tr_b16 v[62:63], v34 offset:1024
ds_read_b64_tr_b16 v[64:65], v35 offset:0
ds_read_b64_tr_b16 v[66:67], v35 offset:1024
v_mfma_f32_32x32x16_bf16 v[108:123], v[80:83], a[28:31], v[108:123]
ds_read_b64_tr_b16 v[68:69], v36 offset:0
ds_read_b64_tr_b16 v[70:71], v36 offset:1024
v_mfma_f32_32x32x16_bf16 v[124:139], v[84:87], a[28:31], v[124:139]
ds_read_b64_tr_b16 v[72:73], v37 offset:0
ds_read_b64_tr_b16 v[74:75], v37 offset:1024
v_mfma_f32_32x32x16_bf16 v[140:155], v[88:91], a[28:31], v[140:155]
buffer_load_dwordx4 v11, s[40:43], s101 offen offset:2048 lds
s_waitcnt lgkmcnt(4)
v_mfma_f32_32x32x16_bf16 v[92:107], v[60:63], a[32:35], v[92:107]
ds_read_b64_tr_b16 v[76:77], v34 offset:4096
ds_read_b64_tr_b16 v[78:79], v34 offset:5120
ds_read_b64_tr_b16 v[80:81], v35 offset:4096
ds_read_b64_tr_b16 v[82:83], v35 offset:5120
v_mfma_f32_32x32x16_bf16 v[108:123], v[64:67], a[32:35], v[108:123]
ds_read_b64_tr_b16 v[84:85], v36 offset:4096
ds_read_b64_tr_b16 v[86:87], v36 offset:5120
s_waitcnt lgkmcnt(6)
v_mfma_f32_32x32x16_bf16 v[124:139], v[68:71], a[32:35], v[124:139]
ds_read_b64_tr_b16 v[88:89], v37 offset:4096
ds_read_b64_tr_b16 v[90:91], v37 offset:5120
v_mfma_f32_32x32x16_bf16 v[140:155], v[72:75], a[32:35], v[140:155]
buffer_load_dwordx4 v12, s[40:43], s101 offen offset:3072 lds
s_waitcnt lgkmcnt(4)
v_mfma_f32_32x32x16_bf16 v[92:107], v[76:79], a[36:39], v[92:107]
ds_read_b64_tr_b16 v[60:61], v34 offset:8192
ds_read_b64_tr_b16 v[62:63], v34 offset:9216
ds_read_b64_tr_b16 v[64:65], v35 offset:8192
ds_read_b64_tr_b16 v[66:67], v35 offset:9216
v_mfma_f32_32x32x16_bf16 v[108:123], v[80:83], a[36:39], v[108:123]
ds_read_b64_tr_b16 v[68:69], v36 offset:8192
ds_read_b64_tr_b16 v[70:71], v36 offset:9216
s_waitcnt lgkmcnt(6)
v_mfma_f32_32x32x16_bf16 v[124:139], v[84:87], a[36:39], v[124:139]
ds_read_b64_tr_b16 v[72:73], v37 offset:8192
ds_read_b64_tr_b16 v[74:75], v37 offset:9216
v_mfma_f32_32x32x16_bf16 v[140:155], v[88:91], a[36:39], v[140:155]
s_mul_i32 s101, s68, 229376
s_add_u32 m0, s46, 114688
s_nop 0
buffer_load_dwordx4 v9, s[40:43], s101 offen offset:0 lds
s_waitcnt lgkmcnt(4)
v_mfma_f32_32x32x16_bf16 v[92:107], v[60:63], a[40:43], v[92:107]
ds_read_b64_tr_b16 v[76:77], v34 offset:12288
ds_read_b64_tr_b16 v[78:79], v34 offset:13312
ds_read_b64_tr_b16 v[80:81], v35 offset:12288
ds_read_b64_tr_b16 v[82:83], v35 offset:13312
v_mfma_f32_32x32x16_bf16 v[108:123], v[64:67], a[40:43], v[108:123]
ds_read_b64_tr_b16 v[84:85], v36 offset:12288
ds_read_b64_tr_b16 v[86:87], v36 offset:13312
s_waitcnt lgkmcnt(6)
v_mfma_f32_32x32x16_bf16 v[124:139], v[68:71], a[40:43], v[124:139]
ds_read_b64_tr_b16 v[88:89], v37 offset:12288
ds_read_b64_tr_b16 v[90:91], v37 offset:13312
v_mfma_f32_32x32x16_bf16 v[140:155], v[72:75], a[40:43], v[140:155]
buffer_load_dwordx4 v10, s[40:43], s101 offen offset:1024 lds
s_waitcnt lgkmcnt(0)
s_waitcnt vmcnt(15)
s_waitcnt vmcnt(14)
s_barrier
v_mfma_f32_32x32x16_bf16 v[92:107], v[76:79], a[44:47], v[92:107]
ds_read_b64_tr_b16 v[60:61], v34 offset:28672
ds_read_b64_tr_b16 v[62:63], v34 offset:29696
ds_read_b64_tr_b16 v[64:65], v35 offset:28672
ds_read_b64_tr_b16 v[66:67], v35 offset:29696
v_mfma_f32_32x32x16_bf16 v[108:123], v[80:83], a[44:47], v[108:123]
ds_read_b64_tr_b16 v[68:69], v36 offset:28672
ds_read_b64_tr_b16 v[70:71], v36 offset:29696
v_mfma_f32_32x32x16_bf16 v[124:139], v[84:87], a[44:47], v[124:139]
ds_read_b64_tr_b16 v[72:73], v37 offset:28672
ds_read_b64_tr_b16 v[74:75], v37 offset:29696
s_lshl_b32 s20, s44, 8
s_lshl_b32 s21, s45, 2
s_add_u32 s20, s20, s21
s_add_u32 s20, s20, 0xf10000
v_mfma_f32_32x32x16_bf16 v[140:155], v[88:91], a[44:47], v[140:155]
buffer_load_dwordx4 v11, s[40:43], s101 offen offset:2048 lds
s_cmp_lg_u32 s16, 0
s_cbranch_scc1 nofl_3
v_mov_b32 v220, s17
v_mov_b32 v221, 0
s_mov_b64 exec, 1
buffer_store_dword v220, v221, s[4:7], s20 offen sc1
s_mov_b64 exec, -1
nofl_3:
s_waitcnt lgkmcnt(4)
v_mfma_f32_32x32x16_bf16 v[92:107], v[60:63], a[48:51], v[92:107]
ds_read_b64_tr_b16 v[76:77], v34 offset:32768
ds_read_b64_tr_b16 v[78:79], v34 offset:33792
ds_read_b64_tr_b16 v[80:81], v35 offset:32768
ds_read_b64_tr_b16 v[82:83], v35 offset:33792
s_mov_b32 s24, s10
s_mov_b32 s25, s11
s_mov_b32 s26, 0x1c0000
v_mfma_f32_32x32x16_bf16 v[108:123], v[64:67], a[48:51], v[108:123]
ds_read_b64_tr_b16 v[84:85], v36 offset:32768
ds_read_b64_tr_b16 v[86:87], v36 offset:33792
s_mov_b32 s27, 0x20000
s_mul_i32 s20, s19, 112
s_mul_i32 s21, s16, 28
s_add_u32 s20, s20, s21
s_add_u32 s20, s20, 0
s_waitcnt lgkmcnt(6)
v_mfma_f32_32x32x16_bf16 v[124:139], v[68:71], a[48:51], v[124:139]
ds_read_b64_tr_b16 v[88:89], v37 offset:32768
ds_read_b64_tr_b16 v[90:91], v37 offset:33792
v_add_u32 v223, s20, v1
v_lshrrev_b32 v224, 3, v223
v_and_b32 v225, 1, v224
v_mul_u32_u24 v225, 896, v225
v_lshrrev_b32 v224, 1, v224
v_mfma_f32_32x32x16_bf16 v[140:155], v[72:75], a[48:51], v[140:155]
buffer_load_dwordx4 v12, s[40:43], s101 offen offset:3072 lds
v_add_u32 v224, v224, v225
v_lshlrev_b32 v224, 10, v224
v_and_b32 v225, 7, v223
v_lshlrev_b32 v225, 7, v225
v_add_u32 v224, v224, v225
v_mov_b32 v225, 0x7ff00000
s_waitcnt lgkmcnt(4)
v_mfma_f32_32x32x16_bf16 v[92:107], v[76:79], a[52:55], v[92:107]
ds_read_b64_tr_b16 v[60:61], v34 offset:36864
ds_read_b64_tr_b16 v[62:63], v34 offset:37888
ds_read_b64_tr_b16 v[64:65], v35 offset:36864
ds_read_b64_tr_b16 v[66:67], v35 offset:37888
s_mov_b32 s22, 28
v_cmp_gt_u32 s[20:21], s22, v1
s_nop 1
v_cndmask_b32 v224, v225, v224, s[20:21]
v_mfma_f32_32x32x16_bf16 v[108:123], v[80:83], a[52:55], v[108:123]
ds_read_b64_tr_b16 v[68:69], v36 offset:36864
ds_read_b64_tr_b16 v[70:71], v36 offset:37888
s_mov_b32 s22, 14336
v_cmp_gt_u32 s[20:21], s22, v223
s_nop 1
v_cndmask_b32 v224, v225, v224, s[20:21]
buffer_load_dword v245, v224, s[24:27], 0 offen
s_waitcnt lgkmcnt(6)
v_mfma_f32_32x32x16_bf16 v[124:139], v[84:87], a[52:55], v[124:139]
ds_read_b64_tr_b16 v[72:73], v37 offset:36864
ds_read_b64_tr_b16 v[74:75], v37 offset:37888
v_mfma_f32_32x32x16_bf16 v[140:155], v[88:91], a[52:55], v[140:155]
s_mul_i32 s101, s69, 229376
s_add_u32 m0, s46, 0
s_nop 0
buffer_load_dwordx4 v9, s[40:43], s101 offen offset:0 lds
s_waitcnt lgkmcnt(4)
v_mfma_f32_32x32x16_bf16 v[92:107], v[60:63], a[56:59], v[92:107]
ds_read_b64_tr_b16 v[76:77], v34 offset:40960
ds_read_b64_tr_b16 v[78:79], v34 offset:41984
ds_read_b64_tr_b16 v[80:81], v35 offset:40960
ds_read_b64_tr_b16 v[82:83], v35 offset:41984
v_mfma_f32_32x32x16_bf16 v[108:123], v[64:67], a[56:59], v[108:123]
ds_read_b64_tr_b16 v[84:85], v36 offset:40960
ds_read_b64_tr_b16 v[86:87], v36 offset:41984
s_waitcnt lgkmcnt(6)
v_mfma_f32_32x32x16_bf16 v[124:139], v[68:71], a[56:59], v[124:139]
ds_read_b64_tr_b16 v[88:89], v37 offset:40960
ds_read_b64_tr_b16 v[90:91], v37 offset:41984
v_mfma_f32_32x32x16_bf16 v[140:155], v[72:75], a[56:59], v[140:155]
buffer_load_dwordx4 v10, s[40:43], s101 offen offset:1024 lds
s_waitcnt lgkmcnt(0)
s_waitcnt vmcnt(13)
s_barrier
v_mfma_f32_32x32x16_bf16 v[92:107], v[76:79], a[60:63], v[92:107]
ds_read_b64_tr_b16 v[60:61], v38 offset:0
ds_read_b64_tr_b16 v[62:63], v38 offset:1024
ds_read_b64_tr_b16 v[64:65], v39 offset:0
ds_read_b64_tr_b16 v[66:67], v39 offset:1024
v_mfma_f32_32x32x16_bf16 v[108:123], v[80:83], a[60:63], v[108:123]
ds_read_b64_tr_b16 v[68:69], v40 offset:0
ds_read_b64_tr_b16 v[70:71], v40 offset:1024
v_mfma_f32_32x32x16_bf16 v[124:139], v[84:87], a[60:63], v[124:139]
ds_read_b64_tr_b16 v[72:73], v41 offset:0
ds_read_b64_tr_b16 v[74:75], v41 offset:1024
s_mov_b32 s24, s10
s_mov_b32 s25, s11
s_mov_b32 s26, 0x1c0000
s_mov_b32 s27, 0x20000
s_mul_i32 s20, s19, 112
v_mfma_f32_32x32x16_bf16 v[140:155], v[88:91], a[60:63], v[140:155]
buffer_load_dwordx4 v11, s[40:43], s101 offen offset:2048 lds
s_mul_i32 s21, s16, 28
s_add_u32 s20, s20, s21
s_add_u32 s20, s20, 3584
v_add_u32 v223, s20, v1
v_lshrrev_b32 v224, 3, v223
v_and_b32 v225, 1, v224
s_waitcnt lgkmcnt(4)
v_mfma_f32_32x32x16_bf16 v[92:107], v[60:63], a[64:67], v[92:107]
ds_read_b64_tr_b16 v[76:77], v38 offset:4096
ds_read_b64_tr_b16 v[78:79], v38 offset:5120
ds_read_b64_tr_b16 v[80:81], v39 offset:4096
ds_read_b64_tr_b16 v[82:83], v39 offset:5120
v_mul_u32_u24 v225, 896, v225
v_lshrrev_b32 v224, 1, v224
v_add_u32 v224, v224, v225
v_mfma_f32_32x32x16_bf16 v[108:123], v[64:67], a[64:67], v[108:123]
ds_read_b64_tr_b16 v[84:85], v40 offset:4096
ds_read_b64_tr_b16 v[86:87], v40 offset:5120
v_lshlrev_b32 v224, 10, v224
v_and_b32 v225, 7, v223
v_lshlrev_b32 v225, 7, v225
v_add_u32 v224, v224, v225
v_mov_b32 v225, 0x7ff00000
s_waitcnt lgkmcnt(6)
v_mfma_f32_32x32x16_bf16 v[124:139], v[68:71], a[64:67], v[124:139]
ds_read_b64_tr_b16 v[88:89], v41 offset:4096
ds_read_b64_tr_b16 v[90:91], v41 offset:5120
s_mov_b32 s22, 28
v_cmp_gt_u32 s[20:21], s22, v1
s_nop 1
v_cndmask_b32 v224, v225, v224, s[20:21]
s_mov_b32 s22, 14336
v_cmp_gt_u32 s[20:21], s22, v223
v_mfma_f32_32x32x16_bf16 v[140:155], v[72:75], a[64:67], v[140:155]
buffer_load_dwordx4 v12, s[40:43], s101 offen offset:3072 lds
v_cndmask_b32 v224, v225, v224, s[20:21]
buffer_load_dword v245, v224, s[24:27], 0 offen
s_waitcnt lgkmcnt(4)
v_mfma_f32_32x32x16_bf16 v[92:107], v[76:79], a[68:71], v[92:107]
ds_read_b64_tr_b16 v[60:61], v38 offset:8192
ds_read_b64_tr_b16 v[62:63], v38 offset:9216
ds_read_b64_tr_b16 v[64:65], v39 offset:8192
ds_read_b64_tr_b16 v[66:67], v39 offset:9216
v_mfma_f32_32x32x16_bf16 v[108:123], v[80:83], a[68:71], v[108:123]
ds_read_b64_tr_b16 v[68:69], v40 offset:8192
ds_read_b64_tr_b16 v[70:71], v40 offset:9216
s_waitcnt lgkmcnt(6)
v_mfma_f32_32x32x16_bf16 v[124:139], v[84:87], a[68:71], v[124:139]
ds_read_b64_tr_b16 v[72:73], v41 offset:8192
ds_read_b64_tr_b16 v[74:75], v41 offset:9216
v_mfma_f32_32x32x16_bf16 v[140:155], v[88:91], a[68:71], v[140:155]
s_waitcnt lgkmcnt(4)
v_mfma_f32_32x32x16_bf16 v[92:107], v[60:63], a[72:75], v[92:107]
ds_read_b64_tr_b16 v[76:77], v38 offset:12288
ds_read_b64_tr_b16 v[78:79], v38 offset:13312
ds_read_b64_tr_b16 v[80:81], v39 offset:12288
ds_read_b64_tr_b16 v[82:83], v39 offset:13312
v_mfma_f32_32x32x16_bf16 v[108:123], v[64:67], a[72:75], v[108:123]
ds_read_b64_tr_b16 v[84:85], v40 offset:12288
ds_read_b64_tr_b16 v[86:87], v40 offset:13312
s_waitcnt lgkmcnt(6)
v_mfma_f32_32x32x16_bf16 v[124:139], v[68:71], a[72:75], v[124:139]
ds_read_b64_tr_b16 v[88:89], v41 offset:12288
ds_read_b64_tr_b16 v[90:91], v41 offset:13312
v_mfma_f32_32x32x16_bf16 v[140:155], v[72:75], a[72:75], v[140:155]
s_waitcnt lgkmcnt(0)
s_waitcnt vmcnt(10)
s_barrier
v_mfma_f32_32x32x16_bf16 v[92:107], v[76:79], a[76:79], v[92:107]
ds_read_b64_tr_b16 v[60:61], v38 offset:28672
ds_read_b64_tr_b16 v[62:63], v38 offset:29696
ds_read_b64_tr_b16 v[64:65], v39 offset:28672
ds_read_b64_tr_b16 v[66:67], v39 offset:29696
v_mfma_f32_32x32x16_bf16 v[108:123], v[80:83], a[76:79], v[108:123]
ds_read_b64_tr_b16 v[68:69], v40 offset:28672
ds_read_b64_tr_b16 v[70:71], v40 offset:29696
v_mfma_f32_32x32x16_bf16 v[124:139], v[84:87], a[76:79], v[124:139]
ds_read_b64_tr_b16 v[72:73], v41 offset:28672
ds_read_b64_tr_b16 v[74:75], v41 offset:29696
v_lshrrev_b32 v164, 3, v1
v_lshlrev_b32 v164, 11, v164
v_and_b32 v165, 7, v1
v_lshlrev_b32 v165, 5, v165
v_add_u32 v164, v164, v165
v_mfma_f32_32x32x16_bf16 v[140:155], v[88:91], a[76:79], v[140:155]
s_lshl_b32 s20, s45, 4
s_and_b32 s21, s44, 8
s_add_u32 s20, s20, s21
s_lshl_b32 s20, s20, 11
s_lshl_b32 s21, s58, 8
s_add_u32 s20, s20, s21
s_add_u32 s57, s20, 0x1000000
s_waitcnt lgkmcnt(4)
v_mfma_f32_32x32x16_bf16 v[92:107], v[60:63], a[80:83], v[92:107]
ds_read_b64_tr_b16 v[76:77], v38 offset:32768
ds_read_b64_tr_b16 v[78:79], v38 offset:33792
ds_read_b64_tr_b16 v[80:81], v39 offset:32768
ds_read_b64_tr_b16 v[82:83], v39 offset:33792
buffer_load_dwordx4 v[156:159], v164, s[4:7], s57 offen sc1
buffer_load_dwordx4 v[160:163], v164, s[4:7], s57 offen offset:16 sc1
s_mov_b32 s24, s10
v_mfma_f32_32x32x16_bf16 v[108:123], v[64:67], a[80:83], v[108:123]
ds_read_b64_tr_b16 v[84:85], v40 offset:32768
ds_read_b64_tr_b16 v[86:87], v40 offset:33792
s_mov_b32 s25, s11
s_mov_b32 s26, 0x1c0000
s_mov_b32 s27, 0x20000
s_sub_u32 s20, 384, s10
s_and_b32 s20, s20, 0x380
s_waitcnt lgkmcnt(6)
v_mfma_f32_32x32x16_bf16 v[124:139], v[68:71], a[80:83], v[124:139]
ds_read_b64_tr_b16 v[88:89], v41 offset:32768
ds_read_b64_tr_b16 v[90:91], v41 offset:33792
s_lshl_b32 s21, s19, 2
s_add_u32 s21, s21, s16
s_mul_i32 s21, s21, 14336
s_add_u32 s20, s20, s21
v_lshlrev_b32 v223, 10, v1
v_mfma_f32_32x32x16_bf16 v[140:155], v[72:75], a[80:83], v[140:155]
v_mov_b32 v224, 0x7ff00000
s_mov_b32 s22, 14
v_cmp_gt_u32 s[22:23], s22, v1
s_nop 1
v_cndmask_b32 v223, v224, v223, s[22:23]
buffer_load_dword v245, v223, s[24:27], s20 offen
s_mov_b32 s24, s12
s_mov_b32 s25, s13
s_waitcnt lgkmcnt(4)
v_mfma_f32_32x32x16_bf16 v[92:107], v[76:79], a[84:87], v[92:107]
ds_read_b64_tr_b16 v[60:61], v38 offset:36864
ds_read_b64_tr_b16 v[62:63], v38 offset:37888
ds_read_b64_tr_b16 v[64:65], v39 offset:36864
ds_read_b64_tr_b16 v[66:67], v39 offset:37888
s_mov_b32 s26, 0x80000
s_mov_b32 s27, 0x20000
s_sub_u32 s20, 384, s12
v_mfma_f32_32x32x16_bf16 v[108:123], v[80:83], a[84:87], v[108:123]
ds_read_b64_tr_b16 v[68:69], v40 offset:36864
ds_read_b64_tr_b16 v[70:71], v40 offset:37888
s_and_b32 s20, s20, 0x380
s_lshl_b32 s21, s19, 2
s_add_u32 s21, s21, s16
s_mul_i32 s21, s21, 4096
s_add_u32 s20, s20, s21
s_waitcnt lgkmcnt(6)
v_mfma_f32_32x32x16_bf16 v[124:139], v[84:87], a[84:87], v[124:139]
ds_read_b64_tr_b16 v[72:73], v41 offset:36864
ds_read_b64_tr_b16 v[74:75], v41 offset:37888
v_lshlrev_b32 v223, 10, v1
v_mov_b32 v224, 0x7ff00000
s_mov_b32 s22, 4
v_cmp_gt_u32 s[22:23], s22, v1
s_nop 1
v_cndmask_b32 v223, v224, v223, s[22:23]
v_mfma_f32_32x32x16_bf16 v[140:155], v[88:91], a[84:87], v[140:155]
buffer_load_dword v245, v223, s[24:27], s20 offen
s_waitcnt lgkmcnt(4)
v_mfma_f32_32x32x16_bf16 v[92:107], v[60:63], a[88:91], v[92:107]
ds_read_b64_tr_b16 v[76:77], v38 offset:40960
ds_read_b64_tr_b16 v[78:79], v38 offset:41984
ds_read_b64_tr_b16 v[80:81], v39 offset:40960
ds_read_b64_tr_b16 v[82:83], v39 offset:41984
v_mfma_f32_32x32x16_bf16 v[108:123], v[64:67], a[88:91], v[108:123]
ds_read_b64_tr_b16 v[84:85], v40 offset:40960
ds_read_b64_tr_b16 v[86:87], v40 offset:41984
s_waitcnt lgkmcnt(6)
v_mfma_f32_32x32x16_bf16 v[124:139], v[68:71], a[88:91], v[124:139]
ds_read_b64_tr_b16 v[88:89], v41 offset:40960
ds_read_b64_tr_b16 v[90:91], v41 offset:41984
v_mfma_f32_32x32x16_bf16 v[140:155], v[72:75], a[88:91], v[140:155]
s_waitcnt lgkmcnt(0)
s_waitcnt vmcnt(10)
s_barrier
v_mfma_f32_32x32x16_bf16 v[92:107], v[76:79], a[92:95], v[92:107]
ds_read_b64_tr_b16 v[60:61], v42 offset:0
ds_read_b64_tr_b16 v[62:63], v42 offset:1024
ds_read_b64_tr_b16 v[64:65], v43 offset:0
ds_read_b64_tr_b16 v[66:67], v43 offset:1024
v_mfma_f32_32x32x16_bf16 v[108:123], v[80:83], a[92:95], v[108:123]
ds_read_b64_tr_b16 v[68:69], v44 offset:0
ds_read_b64_tr_b16 v[70:71], v44 offset:1024
v_mfma_f32_32x32x16_bf16 v[124:139], v[84:87], a[92:95], v[124:139]
ds_read_b64_tr_b16 v[72:73], v45 offset:0
ds_read_b64_tr_b16 v[74:75], v45 offset:1024
v_mfma_f32_32x32x16_bf16 v[140:155], v[88:91], a[92:95], v[140:155]
s_waitcnt vmcnt(2)
s_mov_b32 s21, 20000
gl_5:
v_xor_b32 v165, s17, v157
v_xor_b32 v159, s17, v159
v_or_b32 v165, v165, v159
v_xor_b32 v161, s17, v161
v_or_b32 v165, v165, v161
v_xor_b32 v163, s17, v163
v_or_b32 v165, v165, v163
v_cmp_ne_u32 vcc, 0, v165
s_cbranch_vccz gok_4
s_sub_u32 s21, s21, 1
s_cmp_eq_u32 s21, 0
s_cbranch_scc1 gok_4
buffer_load_dwordx4 v[156:159], v164, s[4:7], s57 offen sc1
buffer_load_dwordx4 v[160:163], v164, s[4:7], s57 offen offset:16 sc1
s_waitcnt vmcnt(0)
s_branch gl_5
gok_4:
v_add_f32_dpp v156, v156, v156 row_ror:8 row_mask:0xf bank_mask:0xf
s_waitcnt lgkmcnt(4)
v_mfma_f32_32x32x16_bf16 v[92:107], v[60:63], a[96:99], v[92:107]
ds_read_b64_tr_b16 v[76:77], v42 offset:4096
ds_read_b64_tr_b16 v[78:79], v42 offset:5120
ds_read_b64_tr_b16 v[80:81], v43 offset:4096
ds_read_b64_tr_b16 v[82:83], v43 offset:5120
v_add_f32_dpp v158, v158, v158 row_ror:8 row_mask:0xf bank_mask:0xf
v_add_f32_dpp v160, v160, v160 row_ror:8 row_mask:0xf bank_mask:0xf
v_add_f32_dpp v162, v162, v162 row_ror:8 row_mask:0xf bank_mask:0xf
v_mfma_f32_32x32x16_bf16 v[108:123], v[64:67], a[96:99], v[108:123]
ds_read_b64_tr_b16 v[84:85], v44 offset:4096
ds_read_b64_tr_b16 v[86:87], v44 offset:5120
v_permlane16_swap_b32 v156, v158
v_permlane16_swap_b32 v160, v162
v_add_f32 v156, v156, v158
v_add_f32 v160, v160, v162
v_and_b32 v157, 7, v1
s_waitcnt lgkmcnt(6)
v_mfma_f32_32x32x16_bf16 v[124:139], v[68:71], a[96:99], v[124:139]
ds_read_b64_tr_b16 v[88:89], v45 offset:4096
ds_read_b64_tr_b16 v[90:91], v45 offset:5120
v_lshlrev_b32 v157, 4, v157
v_lshrrev_b32 v159, 4, v1
v_lshlrev_b32 v159, 2, v159
v_permlane32_swap_b32 v156, v160
s_lshl_b32 s20, s58, 7
v_mfma_f32_32x32x16_bf16 v[140:155], v[72:75], a[96:99], v[140:155]
s_add_u32 s20, s20, 148992
v_add3_u32 v157, v157, v159, s20
v_add_f32 v156, v156, v160
ds_write_b32 v157, v156
s_lshl_b32 s20, s29, 1
s_sub_u32 s20, s20, 2
v_lshrrev_b32 v220, 4, v1
s_waitcnt lgkmcnt(5)
v_mfma_f32_32x32x16_bf16 v[92:107], v[76:79], a[100:103], v[92:107]
ds_read_b64_tr_b16 v[60:61], v42 offset:8192
ds_read_b64_tr_b16 v[62:63], v42 offset:9216
ds_read_b64_tr_b16 v[64:65], v43 offset:8192
ds_read_b64_tr_b16 v[66:67], v43 offset:9216
v_add_u32 v220, s20, v220
v_max_i32 v220, 0, v220
v_lshlrev_b32 v220, 8, v220
v_mfma_f32_32x32x16_bf16 v[108:123], v[80:83], a[100:103], v[108:123]
ds_read_b64_tr_b16 v[68:69], v44 offset:8192
ds_read_b64_tr_b16 v[70:71], v44 offset:9216
v_and_b32 v221, 15, v1
v_lshlrev_b32 v221, 2, v221
v_add_u32 v229, v220, v221
s_mov_b32 s31, 0xf10000
buffer_load_dword v228, v229, s[4:7], s31 offen sc1
s_waitcnt lgkmcnt(7)
v_mfma_f32_32x32x16_bf16 v[124:139], v[84:87], a[100:103], v[124:139]
ds_read_b64_tr_b16 v[72:73], v45 offset:8192
ds_read_b64_tr_b16 v[74:75], v45 offset:9216
s_lshl_b32 s20, s28, 16
s_lshl_b32 s21, s29, 3
s_lshl_b32 s22, s16, 2
s_add_u32 s21, s21, s22
s_sub_u32 s21, s21, 8
v_mfma_f32_32x32x16_bf16 v[140:155], v[88:91], a[100:103], v[140:155]
s_lshl_b32 s21, s21, 10
s_add_u32 s21, s21, s20
s_add_u32 s33, s21, 0x200000
s_add_u32 s34, s21, 0x400000
s_cmp_eq_u32 s29, 0
s_cselect_b32 s25, 1, 0
s_waitcnt lgkmcnt(4)
v_mfma_f32_32x32x16_bf16 v[92:107], v[60:63], a[104:107], v[92:107]
ds_read_b64_tr_b16 v[76:77], v42 offset:12288
ds_read_b64_tr_b16 v[78:79], v42 offset:13312
ds_read_b64_tr_b16 v[80:81], v43 offset:12288
ds_read_b64_tr_b16 v[82:83], v43 offset:13312
s_cmp_lt_u32 s16, 2
s_cselect_b32 s25, s25, 0
v_mfma_f32_32x32x16_bf16 v[108:123], v[64:67], a[104:107], v[108:123]
ds_read_b64_tr_b16 v[84:85], v44 offset:12288
ds_read_b64_tr_b16 v[86:87], v44 offset:13312
s_cmp_lg_u32 s25, 0
s_cselect_b32 s33, 0x7ff00000, s33
s_cmp_lg_u32 s25, 0
s_cselect_b32 s34, 0x7ff00000, s34
s_lshl_b32 s21, s29, 3
s_waitcnt lgkmcnt(6)
v_mfma_f32_32x32x16_bf16 v[124:139], v[68:71], a[104:107], v[124:139]
ds_read_b64_tr_b16 v[88:89], v45 offset:12288
ds_read_b64_tr_b16 v[90:91], v45 offset:13312
s_lshl_b32 s22, s16, 1
s_add_u32 s21, s21, s22
s_lshl_b32 s21, s21, 10
s_add_u32 s21, s21, s20
s_add_u32 s35, s21, 0x0
v_mfma_f32_32x32x16_bf16 v[140:155], v[72:75], a[104:107], v[140:155]
s_lshl_b32 s36, s16, 12
s_waitcnt lgkmcnt(0)
s_barrier
v_mfma_f32_32x32x16_bf16 v[92:107], v[76:79], a[108:111], v[92:107]
ds_read_b64_tr_b16 v[60:61], v34 offset:0
ds_read_b64_tr_b16 v[62:63], v34 offset:1024
ds_read_b64_tr_b16 v[64:65], v35 offset:0
ds_read_b64_tr_b16 v[66:67], v35 offset:1024
v_mfma_f32_32x32x16_bf16 v[108:123], v[80:83], a[108:111], v[108:123]
ds_read_b64_tr_b16 v[68:69], v36 offset:0
ds_read_b64_tr_b16 v[70:71], v36 offset:1024
v_mfma_f32_32x32x16_bf16 v[124:139], v[84:87], a[108:111], v[124:139]
ds_read_b64_tr_b16 v[72:73], v37 offset:0
ds_read_b64_tr_b16 v[74:75], v37 offset:1024
v_mfma_f32_32x32x16_bf16 v[140:155], v[88:91], a[108:111], v[140:155]
s_waitcnt vmcnt(0)
s_mov_b32 s21, 20000
fl_7:
v_cmp_ne_u32 vcc, s17, v228
s_cbranch_vccz fok_6
s_sub_u32 s21, s21, 1
s_cmp_eq_u32 s21, 0
s_cbranch_scc1 fok_6
buffer_load_dword v228, v229, s[4:7], s31 offen sc1
s_waitcnt vmcnt(0)
s_branch fl_7
fok_6:
s_waitcnt lgkmcnt(4)
v_mfma_f32_32x32x16_bf16 v[92:107], v[60:63], a[112:115], v[92:107]
ds_read_b64_tr_b16 v[76:77], v34 offset:4096
ds_read_b64_tr_b16 v[78:79], v34 offset:5120
ds_read_b64_tr_b16 v[80:81], v35 offset:4096
ds_read_b64_tr_b16 v[82:83], v35 offset:5120
s_add_u32 m0, s36, 114688
s_nop 0
buffer_load_dwordx4 v241, s[4:7], s33 offen offset:0 sc1 lds
buffer_load_dwordx4 v241, s[4:7], s33 offen offset:1024 sc1 lds
v_mfma_f32_32x32x16_bf16 v[108:123], v[64:67], a[112:115], v[108:123]
ds_read_b64_tr_b16 v[84:85], v36 offset:4096
ds_read_b64_tr_b16 v[86:87], v36 offset:5120
buffer_load_dwordx4 v241, s[4:7], s33 offen offset:2048 sc1 lds
buffer_load_dwordx4 v241, s[4:7], s33 offen offset:3072 sc1 lds
s_add_u32 m0, s36, 131072
s_nop 0
buffer_load_dwordx4 v241, s[4:7], s34 offen offset:0 sc1 lds
buffer_load_dwordx4 v241, s[4:7], s34 offen offset:1024 sc1 lds
s_waitcnt lgkmcnt(6)
v_mfma_f32_32x32x16_bf16 v[124:139], v[68:71], a[112:115], v[124:139]
ds_read_b64_tr_b16 v[88:89], v37 offset:4096
ds_read_b64_tr_b16 v[90:91], v37 offset:5120
buffer_load_dwordx4 v241, s[4:7], s34 offen offset:2048 sc1 lds
buffer_load_dwordx4 v241, s[4:7], s34 offen offset:3072 sc1 lds
buffer_load_dwordx4 a[128:131], v241, s[4:7], s35 offen sc1
buffer_load_dwordx4 a[132:135], v241, s[4:7], s35 offen offset:1024 sc1
v_mfma_f32_32x32x16_bf16 v[140:155], v[72:75], a[112:115], v[140:155]
s_waitcnt lgkmcnt(4)
v_mfma_f32_32x32x16_bf16 v[92:107], v[76:79], a[116:119], v[92:107]
ds_read_b64_tr_b16 v[60:61], v34 offset:8192
ds_read_b64_tr_b16 v[62:63], v34 offset:9216
ds_read_b64_tr_b16 v[64:65], v35 offset:8192
ds_read_b64_tr_b16 v[66:67], v35 offset:9216
v_mfma_f32_32x32x16_bf16 v[108:123], v[80:83], a[116:119], v[108:123]
ds_read_b64_tr_b16 v[68:69], v36 offset:8192
ds_read_b64_tr_b16 v[70:71], v36 offset:9216
s_waitcnt lgkmcnt(6)
v_mfma_f32_32x32x16_bf16 v[124:139], v[84:87], a[116:119], v[124:139]
ds_read_b64_tr_b16 v[72:73], v37 offset:8192
ds_read_b64_tr_b16 v[74:75], v37 offset:9216
v_mfma_f32_32x32x16_bf16 v[140:155], v[88:91], a[116:119], v[140:155]
s_waitcnt lgkmcnt(4)
v_mfma_f32_32x32x16_bf16 v[92:107], v[60:63], a[120:123], v[92:107]
ds_read_b64_tr_b16 v[76:77], v34 offset:12288
ds_read_b64_tr_b16 v[78:79], v34 offset:13312
ds_read_b64_tr_b16 v[80:81], v35 offset:12288
ds_read_b64_tr_b16 v[82:83], v35 offset:13312
v_mfma_f32_32x32x16_bf16 v[108:123], v[64:67], a[120:123], v[108:123]
ds_read_b64_tr_b16 v[84:85], v36 offset:12288
ds_read_b64_tr_b16 v[86:87], v36 offset:13312
s_waitcnt lgkmcnt(6)
v_mfma_f32_32x32x16_bf16 v[124:139], v[68:71], a[120:123], v[124:139]
ds_read_b64_tr_b16 v[88:89], v37 offset:12288
ds_read_b64_tr_b16 v[90:91], v37 offset:13312
v_mfma_f32_32x32x16_bf16 v[140:155], v[72:75], a[120:123], v[140:155]
s_waitcnt lgkmcnt(4)
v_mfma_f32_32x32x16_bf16 v[92:107], v[76:79], a[124:127], v[92:107]
v_mfma_f32_32x32x16_bf16 v[108:123], v[80:83], a[124:127], v[108:123]
s_waitcnt lgkmcnt(0)
v_mfma_f32_32x32x16_bf16 v[124:139], v[84:87], a[124:127], v[124:139]
v_mfma_f32_32x32x16_bf16 v[140:155], v[88:91], a[124:127], v[140:155]
s_lshl_b32 s20, s58, 7
v_add_u32 v220, s20, v244
ds_read_b128 v[156:159], v220 offset:512
ds_read_b128 v[160:163], v220 offset:544
ds_read_b128 v[164:167], v220 offset:576
ds_read_b128 v[168:171], v220 offset:608
s_lshl_b32 s20, s59, 7
v_add_u32 v220, s20, v244
ds_read_b128 v[172:175], v220 offset:512
ds_read_b128 v[176:179], v220 offset:544
ds_read_b128 v[180:183], v220 offset:576
ds_read_b128 v[184:187], v220 offset:608
s_lshl_b32 s20, s60, 7
v_add_u32 v220, s20, v244
ds_read_b128 v[188:191], v220 offset:512
ds_read_b128 v[192:195], v220 offset:544
ds_read_b128 v[196:199], v220 offset:576
ds_read_b128 v[200:203], v220 offset:608
s_lshl_b32 s20, s61, 7
v_add_u32 v220, s20, v244
ds_read_b128 v[204:207], v220 offset:512
ds_read_b128 v[208:211], v220 offset:544
ds_read_b128 v[212:215], v220 offset:576
ds_read_b128 v[216:219], v220 offset:608
s_lshl_b32 s22, s53, 2
s_lshl_b32 s21, s58, 1
s_add_u32 s22, s22, s21
s_mul_i32 s21, s51, 112
s_add_u32 s22, s22, s21
s_lshl_b32 s22, s22, 10
s_add_u32 s22, s22, 0x600000
s_add_u32 s23, s22, 1024
s_waitcnt lgkmcnt(12)
v_pk_fma_f32 v[92:93], v[236:237], v[156:157], v[92:93]
v_pk_fma_f32 v[94:95], v[236:237], v[158:159], v[94:95]
v_pk_fma_f32 v[96:97], v[236:237], v[160:161], v[96:97]
v_pk_fma_f32 v[98:99], v[236:237], v[162:163], v[98:99]
v_pk_fma_f32 v[100:101], v[236:237], v[164:165], v[100:101]
v_pk_fma_f32 v[102:103], v[236:237], v[166:167], v[102:103]
v_pk_fma_f32 v[104:105], v[236:237], v[168:169], v[104:105]
v_pk_fma_f32 v[106:107], v[236:237], v[170:171], v[106:107]
v_cvt_pk_bf16_f32 v156, v92, v93
v_cvt_pk_bf16_f32 v157, v94, v95
v_cvt_pk_bf16_f32 v158, v96, v97
v_cvt_pk_bf16_f32 v159, v98, v99
v_cvt_pk_bf16_f32 v160, v100, v101
v_cvt_pk_bf16_f32 v161, v102, v103
v_cvt_pk_bf16_f32 v162, v104, v105
v_cvt_pk_bf16_f32 v163, v106, v107
v_pk_max_i16 v156, v156, 0
v_pk_max_i16 v157, v157, 0
v_pk_max_i16 v158, v158, 0
v_pk_max_i16 v159, v159, 0
v_pk_max_i16 v160, v160, 0
v_pk_max_i16 v161, v161, 0
v_pk_max_i16 v162, v162, 0
v_pk_max_i16 v163, v163, 0
s_cmp_ge_u32 s58, 2
s_cselect_b32 s21, s3, 0
s_cmp_lg_u32 s21, 0
s_cbranch_scc1 nost_8
buffer_store_dwordx4 v[156:159], v241, s[4:7], s22 offen sc1
buffer_store_dwordx4 v[160:163], v241, s[4:7], s23 offen sc1
nost_8:
s_lshl_b32 s22, s53, 2
s_lshl_b32 s21, s59, 1
s_add_u32 s22, s22, s21
s_mul_i32 s21, s51, 112
s_add_u32 s22, s22, s21
s_lshl_b32 s22, s22, 10
s_add_u32 s22, s22, 0x600000
s_add_u32 s23, s22, 1024
s_waitcnt lgkmcnt(8)
v_pk_fma_f32 v[108:109], v[236:237], v[172:173], v[108:109]
v_pk_fma_f32 v[110:111], v[236:237], v[174:175], v[110:111]
v_pk_fma_f32 v[112:113], v[236:237], v[176:177], v[112:113]
v_pk_fma_f32 v[114:115], v[236:237], v[178:179], v[114:115]
v_pk_fma_f32 v[116:117], v[236:237], v[180:181], v[116:117]
v_pk_fma_f32 v[118:119], v[236:237], v[182:183], v[118:119]
v_pk_fma_f32 v[120:121], v[236:237], v[184:185], v[120:121]
v_pk_fma_f32 v[122:123], v[236:237], v[186:187], v[122:123]
v_cvt_pk_bf16_f32 v172, v108, v109
v_cvt_pk_bf16_f32 v173, v110, v111
v_cvt_pk_bf16_f32 v174, v112, v113
v_cvt_pk_bf16_f32 v175, v114, v115
v_cvt_pk_bf16_f32 v176, v116, v117
v_cvt_pk_bf16_f32 v177, v118, v119
v_cvt_pk_bf16_f32 v178, v120, v121
v_cvt_pk_bf16_f32 v179, v122, v123
v_pk_max_i16 v172, v172, 0
v_pk_max_i16 v173, v173, 0
v_pk_max_i16 v174, v174, 0
v_pk_max_i16 v175, v175, 0
v_pk_max_i16 v176, v176, 0
v_pk_max_i16 v177, v177, 0
v_pk_max_i16 v178, v178, 0
v_pk_max_i16 v179, v179, 0
s_cmp_ge_u32 s59, 2
s_cselect_b32 s21, s3, 0
s_cmp_lg_u32 s21, 0
s_cbranch_scc1 nost_9
buffer_store_dwordx4 v[172:175], v241, s[4:7], s22 offen sc1
buffer_store_dwordx4 v[176:179], v241, s[4:7], s23 offen sc1
nost_9:
s_lshl_b32 s22, s53, 2
s_lshl_b32 s21, s60, 1
s_add_u32 s22, s22, s21
s_mul_i32 s21, s51, 112
s_add_u32 s22, s22, s21
s_lshl_b32 s22, s22, 10
s_add_u32 s22, s22, 0x600000
s_add_u32 s23, s22, 1024
s_waitcnt lgkmcnt(4)
v_pk_fma_f32 v[124:125], v[236:237], v[188:189], v[124:125]
v_pk_fma_f32 v[126:127], v[236:237], v[190:191], v[126:127]
v_pk_fma_f32 v[128:129], v[236:237], v[192:193], v[128:129]
v_pk_fma_f32 v[130:131], v[236:237], v[194:195], v[130:131]
v_pk_fma_f32 v[132:133], v[236:237], v[196:197], v[132:133]
v_pk_fma_f32 v[134:135], v[236:237], v[198:199], v[134:135]
v_pk_fma_f32 v[136:137], v[236:237], v[200:201], v[136:137]
v_pk_fma_f32 v[138:139], v[236:237], v[202:203], v[138:139]
v_cvt_pk_bf16_f32 v188, v124, v125
v_cvt_pk_bf16_f32 v189, v126, v127
v_cvt_pk_bf16_f32 v190, v128, v129
v_cvt_pk_bf16_f32 v191, v130, v131
v_cvt_pk_bf16_f32 v192, v132, v133
v_cvt_pk_bf16_f32 v193, v134, v135
v_cvt_pk_bf16_f32 v194, v136, v137
v_cvt_pk_bf16_f32 v195, v138, v139
v_pk_max_i16 v188, v188, 0
v_pk_max_i16 v189, v189, 0
v_pk_max_i16 v190, v190, 0
v_pk_max_i16 v191, v191, 0
v_pk_max_i16 v192, v192, 0
v_pk_max_i16 v193, v193, 0
v_pk_max_i16 v194, v194, 0
v_pk_max_i16 v195, v195, 0
s_cmp_ge_u32 s60, 2
s_cselect_b32 s21, s3, 0
s_cmp_lg_u32 s21, 0
s_cbranch_scc1 nost_10
buffer_store_dwordx4 v[188:191], v241, s[4:7], s22 offen sc1
buffer_store_dwordx4 v[192:195], v241, s[4:7], s23 offen sc1
nost_10:
s_lshl_b32 s22, s53, 2
s_lshl_b32 s21, s61, 1
s_add_u32 s22, s22, s21
s_mul_i32 s21, s51, 112
s_add_u32 s22, s22, s21
s_lshl_b32 s22, s22, 10
s_add_u32 s22, s22, 0x600000
s_add_u32 s23, s22, 1024
s_waitcnt lgkmcnt(0)
v_pk_fma_f32 v[140:141], v[236:237], v[204:205], v[140:141]
v_pk_fma_f32 v[142:143], v[236:237], v[206:207], v[142:143]
v_pk_fma_f32 v[144:145], v[236:237], v[208:209], v[144:145]
v_pk_fma_f32 v[146:147], v[236:237], v[210:211], v[146:147]
v_pk_fma_f32 v[148:149], v[236:237], v[212:213], v[148:149]
v_pk_fma_f32 v[150:151], v[236:237], v[214:215], v[150:151]
v_pk_fma_f32 v[152:153], v[236:237], v[216:217], v[152:153]
v_pk_fma_f32 v[154:155], v[236:237], v[218:219], v[154:155]
v_cvt_pk_bf16_f32 v204, v140, v141
v_cvt_pk_bf16_f32 v205, v142, v143
v_cvt_pk_bf16_f32 v206, v144, v145
v_cvt_pk_bf16_f32 v207, v146, v147
v_cvt_pk_bf16_f32 v208, v148, v149
v_cvt_pk_bf16_f32 v209, v150, v151
v_cvt_pk_bf16_f32 v210, v152, v153
v_cvt_pk_bf16_f32 v211, v154, v155
v_pk_max_i16 v204, v204, 0
v_pk_max_i16 v205, v205, 0
v_pk_max_i16 v206, v206, 0
v_pk_max_i16 v207, v207, 0
v_pk_max_i16 v208, v208, 0
v_pk_max_i16 v209, v209, 0
v_pk_max_i16 v210, v210, 0
v_pk_max_i16 v211, v211, 0
s_cmp_ge_u32 s61, 2
s_cselect_b32 s21, s3, 0
s_cmp_lg_u32 s21, 0
s_cbranch_scc1 nost_11
buffer_store_dwordx4 v[204:207], v241, s[4:7], s22 offen sc1
buffer_store_dwordx4 v[208:211], v241, s[4:7], s23 offen sc1
nost_11:
s_lshl_b32 s20, s18, 2
s_lshr_b32 s21, s19, 3
s_add_u32 s48, s20, s21
s_and_b32 s49, s19, 7
s_and_b32 s50, s16, 1
s_lshr_b32 s51, s16, 1
v_lshlrev_b32 v2, 4, v1
s_lshl_b32 s20, s49, 7
s_add_u32 s32, s10, s20
s_addc_u32 s33, s11, 0
s_sub_u32 s34, 1835008, s20
s_mov_b32 s35, 0x20000
s_add_u32 s36, s12, s20
s_addc_u32 s37, s13, 0
s_sub_u32 s38, 524288, s20
s_mov_b32 s39, 0x20000
v_lshrrev_b32 v32, 3, v1
v_lshlrev_b32 v32, 10, v32
v_bfe_u32 v33, v1, 2, 1
v_bfe_u32 v34, v1, 4, 1
v_xor_b32 v33, v33, v34
v_lshlrev_b32 v33, 6, v33
v_add_u32 v32, v32, v33
v_and_b32 v33, 3, v1
v_lshlrev_b32 v33, 4, v33
v_add_u32 v3, v32, v33
v_add_u32 v4, 7168, v3
v_add_u32 v5, 14336, v3
v_add_u32 v6, 21504, v3
s_lshl_b32 s52, s50, 12
s_lshl_b32 s20, s50, 15
s_mul_i32 s21, s51, 917504
s_add_u32 s53, s20, s21
s_lshl_b32 s21, s51, 18
s_add_u32 s44, s20, s21
s_lshl_b32 s20, s51, 13
s_add_u32 s52, s52, s20
s_lshl_b32 s21, s29, 3
s_lshl_b32 s22, s16, 1
s_add_u32 s47, s21, s22
s_lshl_b32 s22, s16, 1
s_sub_u32 s22, 8, s22
s_cmp_eq_u32 s29, 0
s_cselect_b32 s46, s22, 0
v_mov_b32 v40, 0x3f803f80
v_mov_b32 v41, 0x3f803f80
v_mov_b32 v42, 0x3f803f80
v_mov_b32 v43, 0x3f803f80
v_add_u32 v33, 147456, v2
ds_write_b128 v33, v[40:43]
v_and_b32 v33, 31, v1
v_lshrrev_b32 v34, 5, v1
v_lshlrev_b32 v34, 2, v34
v_sub_u32 v33, v33, v34
v_mov_b32 v35, 0xf149f2ca
v_mov_b32 v36, 0
s_cmp_lg_u32 s46, 0
s_cselect_b64 s[24:25], -1, 0
v_cndmask_b32 v39, v36, v35, s[24:25]
v_cmp_ge_i32 s[54:55], v33, 0
v_cmp_ge_i32 s[56:57], v33, 1
v_mov_b32 v136, v39
v_cndmask_b32 v120, v35, v36, s[54:55]
v_cndmask_b32 v104, v39, v35, s[54:55]
v_cmp_ge_i32 s[54:55], v33, 2
v_mov_b32 v137, v39
v_cndmask_b32 v121, v35, v36, s[56:57]
v_cndmask_b32 v105, v39, v35, s[56:57]
v_cmp_ge_i32 s[56:57], v33, 3
v_mov_b32 v138, v39
v_cndmask_b32 v122, v35, v36, s[54:55]
v_cndmask_b32 v106, v39, v35, s[54:55]
v_cmp_ge_i32 s[54:55], v33, 8
v_mov_b32 v139, v39
v_cndmask_b32 v123, v35, v36, s[56:57]
v_cndmask_b32 v107, v39, v35, s[56:57]
v_cmp_ge_i32 s[56:57], v33, 9
v_mov_b32 v140, v39
v_cndmask_b32 v124, v35, v36, s[54:55]
v_cndmask_b32 v108, v39, v35, s[54:55]
v_cmp_ge_i32 s[54:55], v33, 10
v_mov_b32 v141, v39
v_cndmask_b32 v125, v35, v36, s[56:57]
v_cndmask_b32 v109, v39, v35, s[56:57]
v_cmp_ge_i32 s[56:57], v33, 11
v_mov_b32 v142, v39
v_cndmask_b32 v126, v35, v36, s[54:55]
v_cndmask_b32 v110, v39, v35, s[54:55]
v_cmp_ge_i32 s[54:55], v33, 16
v_mov_b32 v143, v39
v_cndmask_b32 v127, v35, v36, s[56:57]
v_cndmask_b32 v111, v39, v35, s[56:57]
v_cmp_ge_i32 s[56:57], v33, 17
v_mov_b32 v144, v39
v_cndmask_b32 v128, v35, v36, s[54:55]
v_cndmask_b32 v112, v39, v35, s[54:55]
v_cmp_ge_i32 s[54:55], v33, 18
v_mov_b32 v145, v39
v_cndmask_b32 v129, v35, v36, s[56:57]
v_cndmask_b32 v113, v39, v35, s[56:57]
v_cmp_ge_i32 s[56:57], v33, 19
v_mov_b32 v146, v39
v_cndmask_b32 v130, v35, v36, s[54:55]
v_cndmask_b32 v114, v39, v35, s[54:55]
v_cmp_ge_i32 s[54:55], v33, 24
v_mov_b32 v147, v39
v_cndmask_b32 v131, v35, v36, s[56:57]
v_cndmask_b32 v115, v39, v35, s[56:57]
v_cmp_ge_i32 s[56:57], v33, 25
v_mov_b32 v148, v39
v_cndmask_b32 v132, v35, v36, s[54:55]
v_cndmask_b32 v116, v39, v35, s[54:55]
v_cmp_ge_i32 s[54:55], v33, 26
v_mov_b32 v149, v39
v_cndmask_b32 v133, v35, v36, s[56:57]
v_cndmask_b32 v117, v39, v35, s[56:57]
v_cmp_ge_i32 s[56:57], v33, 27
v_mov_b32 v150, v39
v_cndmask_b32 v134, v35, v36, s[54:55]
v_cndmask_b32 v118, v39, v35, s[54:55]
v_mov_b32 v151, v39
v_cndmask_b32 v135, v35, v36, s[56:57]
v_cndmask_b32 v119, v39, v35, s[56:57]
s_lshl_b32 s22, s16, 11
s_add_u32 s23, s22, 114688
v_add_u32 v27, s23, v2
v_bfe_u32 v33, v1, 2, 2
v_lshrrev_b32 v34, 5, v1
v_lshlrev_b32 v35, 2, v34
v_add_u32 v35, v35, v33
v_lshlrev_b32 v35, 5, v35
v_and_b32 v36, 1, v1
v_lshlrev_b32 v36, 4, v36
v_add_u32 v35, v35, v36
v_bfe_u32 v36, v1, 1, 1
v_lshlrev_b32 v36, 3, v36
v_add_u32 v35, v35, v36
s_add_u32 s22, s22, 131072
v_add_u32 v35, s22, v35
v_lshlrev_b32 v36, 7, v34
v_sub_u32 v36, 147584, v36
v_bfe_u32 v37, v1, 4, 1
v_cmp_eq_u32 s[26:27], 1, v37
v_mov_b32 v37, 1024
v_mov_b32 v34, 0
v_cndmask_b32 v28, v35, v36, s[26:27]
v_cndmask_b32 v29, v37, v34, s[26:27]
v_mov_b32 v186, v28
s_cmp_lg_u32 s3, 0
s_cbranch_scc1 kvl_12
s_waitcnt vmcnt(8)
s_branch kvd_13
kvl_12:
s_waitcnt vmcnt(4)
kvd_13:
s_waitcnt lgkmcnt(0)
s_barrier
s_mov_b32 s40, s8
s_mov_b32 s41, s9
s_mov_b32 s42, 0x200000
s_mov_b32 s43, 0x20000
s_lshl_b32 s20, s48, 1
s_add_u32 s20, s20, s50
s_lshl_b32 s22, s20, 15
s_lshl_b32 s23, s49, 7
s_add_u32 s22, s22, s23
s_lshl_b32 s23, s51, 6
s_add_u32 s61, s22, s23
v_and_b32 v32, 31, v1
v_lshlrev_b32 v33, 10, v32
v_lshrrev_b32 v34, 5, v1
v_lshlrev_b32 v34, 4, v34
v_add_u32 v25, v33, v34
s_lshl4_add_u32 s68, s70, s53
s_add_u32 m0, s52, 0
s_nop 0
buffer_load_dwordx4 v3, s[32:35], s68 offen offset:0 lds
buffer_load_dwordx4 v4, s[32:35], s68 offen offset:1024 lds
buffer_load_dwordx4 v5, s[32:35], s68 offen offset:2048 lds
buffer_load_dwordx4 v6, s[32:35], s68 offen offset:3072 lds
s_lshl4_add_u32 s68, s71, s53
s_add_u32 m0, s52, 16384
s_nop 0
buffer_load_dwordx4 v3, s[32:35], s68 offen offset:0 lds
buffer_load_dwordx4 v4, s[32:35], s68 offen offset:1024 lds
buffer_load_dwordx4 v5, s[32:35], s68 offen offset:2048 lds
buffer_load_dwordx4 v6, s[32:35], s68 offen offset:3072 lds
ds_read_b128 a[0:3], v27 offset:0
s_lshl_b32 s20, s48, 1
s_add_u32 s20, s20, s50
s_mul_i32 s22, s20, 112
s_mul_i32 s21, s51, 56
s_add_u32 s22, s22, s21
s_lshl_b32 s22, s22, 10
s_add_u32 s45, s22, 0x600000
s_lshl_b32 s22, s20, 5
s_lshl_b32 s21, s51, 4
s_add_u32 s22, s22, s21
s_lshl_b32 s22, s22, 10
s_add_u32 s60, s22, 0xd00000
s_lshr_b32 s20, s48, 1
s_lshl_b32 s20, s20, 8
s_and_b32 s21, s48, 1
s_lshl_b32 s21, s21, 3
s_add_u32 s20, s20, s21
s_add_u32 s31, s20, 0xf12000
v_bfe_u32 v32, v1, 1, 4
v_lshlrev_b32 v32, 4, v32
v_and_b32 v33, 1, v1
v_lshlrev_b32 v33, 2, v33
v_add_u32 v14, v32, v33
s_waitcnt lgkmcnt(0)
v_mfma_f32_32x32x16_bf16 v[40:55], a[0:3], a[128:131], v[104:119]
ds_read_b128 a[4:7], v27 offset:1024
ds_read_b64_tr_b16 a[8:9], v28 offset:0
ds_read_b64_tr_b16 a[10:11], v28 offset:256
ds_read_b64_tr_b16 a[12:13], v28 offset:512
ds_read_b64_tr_b16 a[14:15], v28 offset:768
v_add_u32 v28, v28, v29
s_lshl4_add_u32 s68, s72, s53
s_add_u32 m0, s52, 32768
s_nop 0
buffer_load_dwordx4 v3, s[32:35], s68 offen offset:0 lds
buffer_load_dwordx4 v4, s[32:35], s68 offen offset:1024 lds
buffer_load_dwordx4 v5, s[32:35], s68 offen offset:2048 lds
buffer_load_dwordx4 v6, s[32:35], s68 offen offset:3072 lds
s_waitcnt lgkmcnt(0)
v_mfma_f32_32x32x16_bf16 v[56:71], a[4:7], a[128:131], v[136:151]
v_exp_f32 v40, v40
ds_read_b128 a[0:3], v27 offset:2048
ds_read_b64_tr_b16 a[16:17], v28 offset:0
v_exp_f32 v41, v41
v_exp_f32 v42, v42
ds_read_b64_tr_b16 a[18:19], v28 offset:256
ds_read_b64_tr_b16 a[20:21], v28 offset:512
v_exp_f32 v43, v43
v_cvt_pk_bf16_f32 v168, v40, v41
v_exp_f32 v44, v44
ds_read_b64_tr_b16 a[22:23], v28 offset:768
v_add_u32 v28, v28, v29
v_exp_f32 v45, v45
v_cvt_pk_bf16_f32 v169, v42, v43
v_exp_f32 v46, v46
s_lshl4_add_u32 s68, s73, s53
s_add_u32 m0, s52, 49152
s_nop 0
buffer_load_dwordx4 v3, s[32:35], s68 offen offset:0 lds
buffer_load_dwordx4 v4, s[32:35], s68 offen offset:1024 lds
v_exp_f32 v47, v47
v_cvt_pk_bf16_f32 v170, v44, v45
v_exp_f32 v48, v48
buffer_load_dwordx4 v5, s[32:35], s68 offen offset:2048 lds
buffer_load_dwordx4 v6, s[32:35], s68 offen offset:3072 lds
v_exp_f32 v49, v49
v_cvt_pk_bf16_f32 v171, v46, v47
v_exp_f32 v50, v50
v_exp_f32 v51, v51
v_cvt_pk_bf16_f32 v172, v48, v49
v_mfma_f32_32x32x16_bf16 a[32:47], a[8:11], v[168:171], 0
v_exp_f32 v52, v52
v_exp_f32 v53, v53
v_cvt_pk_bf16_f32 v173, v50, v51
v_exp_f32 v54, v54
v_exp_f32 v55, v55
v_cvt_pk_bf16_f32 v174, v52, v53
v_mfma_f32_32x32x16_bf16 v[88:103], a[4:7], a[132:135], v[104:119]
v_cvt_pk_bf16_f32 v175, v54, v55
s_nop 1
v_mfma_f32_32x32x16_bf16 a[32:47], a[12:15], v[172:175], a[32:47]
s_cmp_lg_u32 s46, 2
s_cbranch_scc1 tv_14
v_mov_b32 v136, 0
v_mov_b32 v137, 0
v_mov_b32 v138, 0
v_mov_b32 v139, 0
v_mov_b32 v140, 0
v_mov_b32 v141, 0
v_mov_b32 v142, 0
v_mov_b32 v143, 0
v_mov_b32 v144, 0
v_mov_b32 v145, 0
v_mov_b32 v146, 0
v_mov_b32 v147, 0
v_mov_b32 v148, 0
v_mov_b32 v149, 0
v_mov_b32 v150, 0
v_mov_b32 v151, 0
tv_14:
s_waitcnt lgkmcnt(0)
s_nop 0
v_mfma_f32_32x32x16_bf16 v[40:55], a[0:3], a[128:131], v[136:151]
v_exp_f32 v56, v56
ds_read_b128 a[4:7], v27 offset:3072
v_exp_f32 v57, v57
v_exp_f32 v58, v58
ds_read_b64_tr_b16 a[24:25], v28 offset:0
v_exp_f32 v59, v59
v_cvt_pk_bf16_f32 v168, v56, v57
v_exp_f32 v60, v60
ds_read_b64_tr_b16 a[26:27], v28 offset:256
v_exp_f32 v61, v61
v_cvt_pk_bf16_f32 v169, v58, v59
v_exp_f32 v62, v62
ds_read_b64_tr_b16 a[28:29], v28 offset:512
v_exp_f32 v63, v63
v_cvt_pk_bf16_f32 v170, v60, v61
v_exp_f32 v64, v64
ds_read_b64_tr_b16 a[30:31], v28 offset:768
v_exp_f32 v65, v65
v_cvt_pk_bf16_f32 v171, v62, v63
v_exp_f32 v66, v66
v_add_u32 v28, v28, v29
v_exp_f32 v67, v67
v_cvt_pk_bf16_f32 v172, v64, v65
v_mfma_f32_32x32x16_bf16 a[32:47], a[16:19], v[168:171], a[32:47]
v_exp_f32 v68, v68
s_waitcnt vmcnt(16)
v_mov_b32 v32, s17
v_mov_b32 v33, 0
s_mov_b64 exec, 1
buffer_store_dword v32, v33, s[4:7], s30 offen sc1
s_mov_b64 exec, -1
v_exp_f32 v69, v69
v_cvt_pk_bf16_f32 v173, v66, v67
v_exp_f32 v70, v70
s_lshl4_add_u32 s68, s74, s53
s_add_u32 m0, s52, 65536
s_nop 0
buffer_load_dwordx4 v3, s[32:35], s68 offen offset:0 lds
v_exp_f32 v71, v71
v_cvt_pk_bf16_f32 v174, v68, v69
v_mfma_f32_32x32x16_bf16 v[72:87], a[0:3], a[132:135], v[136:151]
v_exp_f32 v88, v88
buffer_load_dwordx4 v4, s[32:35], s68 offen offset:1024 lds
v_exp_f32 v89, v89
v_cvt_pk_bf16_f32 v175, v70, v71
v_exp_f32 v90, v90
buffer_load_dwordx4 v5, s[32:35], s68 offen offset:2048 lds
v_exp_f32 v91, v91
v_cvt_pk_bf16_f32 v176, v88, v89
v_mfma_f32_32x32x16_bf16 a[32:47], a[20:23], v[172:175], a[32:47]
v_exp_f32 v92, v92
buffer_load_dwordx4 v6, s[32:35], s68 offen offset:3072 lds
v_exp_f32 v93, v93
v_cvt_pk_bf16_f32 v177, v90, v91
v_exp_f32 v94, v94
v_exp_f32 v95, v95
v_cvt_pk_bf16_f32 v178, v92, v93
v_exp_f32 v96, v96
v_exp_f32 v97, v97
v_cvt_pk_bf16_f32 v179, v94, v95
v_exp_f32 v98, v98
v_exp_f32 v99, v99
v_cvt_pk_bf16_f32 v180, v96, v97
v_mfma_f32_32x32x16_bf16 a[48:63], a[16:19], v[176:179], 0
v_exp_f32 v100, v100
v_exp_f32 v101, v101
v_cvt_pk_bf16_f32 v181, v98, v99
v_exp_f32 v102, v102
v_exp_f32 v103, v103
v_cvt_pk_bf16_f32 v182, v100, v101
s_waitcnt lgkmcnt(0)
v_mfma_f32_32x32x16_bf16 v[56:71], a[4:7], a[128:131], v[136:151]
v_exp_f32 v40, v40
ds_read_b128 a[0:3], v27 offset:4096
v_exp_f32 v41, v41
v_cvt_pk_bf16_f32 v183, v102, v103
v_exp_f32 v42, v42
ds_read_b64_tr_b16 a[8:9], v28 offset:0
v_exp_f32 v43, v43
v_cvt_pk_bf16_f32 v168, v40, v41
v_mfma_f32_32x32x16_bf16 a[48:63], a[20:23], v[180:183], a[48:63]
v_exp_f32 v44, v44
ds_read_b64_tr_b16 a[10:11], v28 offset:256
v_exp_f32 v45, v45
v_cvt_pk_bf16_f32 v169, v42, v43
v_exp_f32 v46, v46
ds_read_b64_tr_b16 a[12:13], v28 offset:512
v_exp_f32 v47, v47
v_cvt_pk_bf16_f32 v170, v44, v45
v_exp_f32 v48, v48
ds_read_b64_tr_b16 a[14:15], v28 offset:768
v_exp_f32 v49, v49
v_cvt_pk_bf16_f32 v171, v46, v47
v_exp_f32 v50, v50
v_add_u32 v28, v28, v29
v_exp_f32 v51, v51
v_cvt_pk_bf16_f32 v172, v48, v49
v_mfma_f32_32x32x16_bf16 a[32:47], a[24:27], v[168:171], a[32:47]
v_exp_f32 v52, v52
s_lshl4_add_u32 s68, s75, s53
s_add_u32 m0, s52, 81920
s_nop 0
buffer_load_dwordx4 v3, s[32:35], s68 offen offset:0 lds
v_exp_f32 v53, v53
v_cvt_pk_bf16_f32 v173, v50, v51
v_exp_f32 v54, v54
buffer_load_dwordx4 v4, s[32:35], s68 offen offset:1024 lds
v_exp_f32 v55, v55
v_cvt_pk_bf16_f32 v174, v52, v53
v_mfma_f32_32x32x16_bf16 v[88:103], a[4:7], a[132:135], v[136:151]
v_exp_f32 v72, v72
buffer_load_dwordx4 v5, s[32:35], s68 offen offset:2048 lds
v_exp_f32 v73, v73
v_cvt_pk_bf16_f32 v175, v54, v55
v_exp_f32 v74, v74
buffer_load_dwordx4 v6, s[32:35], s68 offen offset:3072 lds
v_exp_f32 v75, v75
v_cvt_pk_bf16_f32 v176, v72, v73
v_mfma_f32_32x32x16_bf16 a[32:47], a[28:31], v[172:175], a[32:47]
v_exp_f32 v76, v76
v_exp_f32 v77, v77
v_cvt_pk_bf16_f32 v177, v74, v75
v_exp_f32 v78, v78
v_exp_f32 v79, v79
v_cvt_pk_bf16_f32 v178, v76, v77
v_exp_f32 v80, v80
v_exp_f32 v81, v81
v_cvt_pk_bf16_f32 v179, v78, v79
v_exp_f32 v82, v82
v_exp_f32 v83, v83
v_cvt_pk_bf16_f32 v180, v80, v81
v_mfma_f32_32x32x16_bf16 a[48:63], a[24:27], v[176:179], a[48:63]
v_exp_f32 v84, v84
v_exp_f32 v85, v85
v_cvt_pk_bf16_f32 v181, v82, v83
v_exp_f32 v86, v86
v_exp_f32 v87, v87
v_cvt_pk_bf16_f32 v182, v84, v85
s_cmp_lg_u32 s46, 4
s_cbranch_scc1 tv_15
v_mov_b32 v136, 0
v_mov_b32 v137, 0
v_mov_b32 v138, 0
v_mov_b32 v139, 0
v_mov_b32 v140, 0
v_mov_b32 v141, 0
v_mov_b32 v142, 0
v_mov_b32 v143, 0
v_mov_b32 v144, 0
v_mov_b32 v145, 0
v_mov_b32 v146, 0
v_mov_b32 v147, 0
v_mov_b32 v148, 0
v_mov_b32 v149, 0
v_mov_b32 v150, 0
v_mov_b32 v151, 0
tv_15:
s_waitcnt lgkmcnt(0)
s_nop 0
v_mfma_f32_32x32x16_bf16 v[40:55], a[0:3], a[128:131], v[136:151]
v_exp_f32 v56, v56
ds_read_b128 a[4:7], v27 offset:5120
v_exp_f32 v57, v57
v_cvt_pk_bf16_f32 v183, v86, v87
v_exp_f32 v58, v58
ds_read_b64_tr_b16 a[16:17], v28 offset:0
v_exp_f32 v59, v59
v_cvt_pk_bf16_f32 v168, v56, v57
v_mfma_f32_32x32x16_bf16 a[48:63], a[28:31], v[180:183], a[48:63]
v_exp_f32 v60, v60
ds_read_b64_tr_b16 a[18:19], v28 offset:256
v_exp_f32 v61, v61
v_cvt_pk_bf16_f32 v169, v58, v59
v_exp_f32 v62, v62
ds_read_b64_tr_b16 a[20:21], v28 offset:512
v_exp_f32 v63, v63
v_cvt_pk_bf16_f32 v170, v60, v61
v_exp_f32 v64, v64
ds_read_b64_tr_b16 a[22:23], v28 offset:768
v_exp_f32 v65, v65
v_cvt_pk_bf16_f32 v171, v62, v63
v_exp_f32 v66, v66
v_add_u32 v28, v28, v29
v_exp_f32 v67, v67
v_cvt_pk_bf16_f32 v172, v64, v65
v_mfma_f32_32x32x16_bf16 a[32:47], a[8:11], v[168:171], a[32:47]
v_exp_f32 v68, v68
s_lshl4_add_u32 s68, s76, s53
s_add_u32 m0, s52, 98304
s_nop 0
buffer_load_dwordx4 v3, s[32:35], s68 offen offset:0 lds
v_exp_f32 v69, v69
v_cvt_pk_bf16_f32 v173, v66, v67
v_exp_f32 v70, v70
buffer_load_dwordx4 v4, s[32:35], s68 offen offset:1024 lds
v_exp_f32 v71, v71
v_cvt_pk_bf16_f32 v174, v68, v69
v_mfma_f32_32x32x16_bf16 v[72:87], a[0:3], a[132:135], v[136:151]
v_exp_f32 v88, v88
buffer_load_dwordx4 v5, s[32:35], s68 offen offset:2048 lds
v_exp_f32 v89, v89
v_cvt_pk_bf16_f32 v175, v70, v71
v_exp_f32 v90, v90
buffer_load_dwordx4 v6, s[32:35], s68 offen offset:3072 lds
v_exp_f32 v91, v91
v_cvt_pk_bf16_f32 v176, v88, v89
v_mfma_f32_32x32x16_bf16 a[32:47], a[12:15], v[172:175], a[32:47]
v_exp_f32 v92, v92
v_exp_f32 v93, v93
v_cvt_pk_bf16_f32 v177, v90, v91
v_exp_f32 v94, v94
v_exp_f32 v95, v95
v_cvt_pk_bf16_f32 v178, v92, v93
v_exp_f32 v96, v96
v_exp_f32 v97, v97
v_cvt_pk_bf16_f32 v179, v94, v95
v_exp_f32 v98, v98
v_exp_f32 v99, v99
v_cvt_pk_bf16_f32 v180, v96, v97
v_mfma_f32_32x32x16_bf16 a[48:63], a[8:11], v[176:179], a[48:63]
v_exp_f32 v100, v100
v_exp_f32 v101, v101
v_cvt_pk_bf16_f32 v181, v98, v99
v_exp_f32 v102, v102
v_exp_f32 v103, v103
v_cvt_pk_bf16_f32 v182, v100, v101
s_waitcnt lgkmcnt(0)
v_mfma_f32_32x32x16_bf16 v[56:71], a[4:7], a[128:131], v[136:151]
v_exp_f32 v40, v40
ds_read_b128 a[0:3], v27 offset:6144
v_exp_f32 v41, v41
v_cvt_pk_bf16_f32 v183, v102, v103
v_exp_f32 v42, v42
ds_read_b64_tr_b16 a[24:25], v28 offset:0
v_exp_f32 v43, v43
v_cvt_pk_bf16_f32 v168, v40, v41
v_mfma_f32_32x32x16_bf16 a[48:63], a[12:15], v[180:183], a[48:63]
v_exp_f32 v44, v44
ds_read_b64_tr_b16 a[26:27], v28 offset:256
v_exp_f32 v45, v45
v_cvt_pk_bf16_f32 v169, v42, v43
v_exp_f32 v46, v46
ds_read_b64_tr_b16 a[28:29], v28 offset:512
v_exp_f32 v47, v47
v_cvt_pk_bf16_f32 v170, v44, v45
v_exp_f32 v48, v48
ds_read_b64_tr_b16 a[30:31], v28 offset:768
v_exp_f32 v49, v49
v_cvt_pk_bf16_f32 v171, v46, v47
v_exp_f32 v50, v50
v_add_u32 v28, v28, v29
v_exp_f32 v51, v51
v_cvt_pk_bf16_f32 v172, v48, v49
v_mfma_f32_32x32x16_bf16 a[32:47], a[16:19], v[168:171], a[32:47]
v_exp_f32 v52, v52
buffer_load_dwordx4 v[16:19], v25, s[40:43], s61 offen
buffer_load_dwordx4 v[20:23], v25, s[40:43], s61 offen offset:32
v_exp_f32 v53, v53
v_cvt_pk_bf16_f32 v173, v50, v51
v_exp_f32 v54, v54
v_exp_f32 v55, v55
v_cvt_pk_bf16_f32 v174, v52, v53
v_mfma_f32_32x32x16_bf16 v[88:103], a[4:7], a[132:135], v[136:151]
v_exp_f32 v72, v72
v_exp_f32 v73, v73
v_cvt_pk_bf16_f32 v175, v54, v55
v_exp_f32 v74, v74
v_exp_f32 v75, v75
v_cvt_pk_bf16_f32 v176, v72, v73
v_mfma_f32_32x32x16_bf16 a[32:47], a[20:23], v[172:175], a[32:47]
v_exp_f32 v76, v76
v_exp_f32 v77, v77
v_cvt_pk_bf16_f32 v177, v74, v75
v_exp_f32 v78, v78
v_exp_f32 v79, v79
v_cvt_pk_bf16_f32 v178, v76, v77
v_exp_f32 v80, v80
v_exp_f32 v81, v81
v_cvt_pk_bf16_f32 v179, v78, v79
v_exp_f32 v82, v82
v_exp_f32 v83, v83
v_cvt_pk_bf16_f32 v180, v80, v81
v_mfma_f32_32x32x16_bf16 a[48:63], a[16:19], v[176:179], a[48:63]
v_exp_f32 v84, v84
v_exp_f32 v85, v85
v_cvt_pk_bf16_f32 v181, v82, v83
v_exp_f32 v86, v86
v_exp_f32 v87, v87
v_cvt_pk_bf16_f32 v182, v84, v85
s_cmp_lg_u32 s46, 6
s_cbranch_scc1 tv_16
v_mov_b32 v136, 0
v_mov_b32 v137, 0
v_mov_b32 v138, 0
v_mov_b32 v139, 0
v_mov_b32 v140, 0
v_mov_b32 v141, 0
v_mov_b32 v142, 0
v_mov_b32 v143, 0
v_mov_b32 v144, 0
v_mov_b32 v145, 0
v_mov_b32 v146, 0
v_mov_b32 v147, 0
v_mov_b32 v148, 0
v_mov_b32 v149, 0
v_mov_b32 v150, 0
v_mov_b32 v151, 0
tv_16:
s_waitcnt lgkmcnt(0)
s_nop 0
v_mfma_f32_32x32x16_bf16 v[40:55], a[0:3], a[128:131], v[136:151]
v_exp_f32 v56, v56
ds_read_b128 a[4:7], v27 offset:7168
v_exp_f32 v57, v57
v_cvt_pk_bf16_f32 v183, v86, v87
v_exp_f32 v58, v58
ds_read_b64_tr_b16 a[8:9], v28 offset:0
v_exp_f32 v59, v59
v_cvt_pk_bf16_f32 v168, v56, v57
v_mfma_f32_32x32x16_bf16 a[48:63], a[20:23], v[180:183], a[48:63]
v_exp_f32 v60, v60
ds_read_b64_tr_b16 a[10:11], v28 offset:256
v_exp_f32 v61, v61
v_cvt_pk_bf16_f32 v169, v58, v59
v_exp_f32 v62, v62
ds_read_b64_tr_b16 a[12:13], v28 offset:512
v_exp_f32 v63, v63
v_cvt_pk_bf16_f32 v170, v60, v61
v_exp_f32 v64, v64
ds_read_b64_tr_b16 a[14:15], v28 offset:768
v_exp_f32 v65, v65
v_cvt_pk_bf16_f32 v171, v62, v63
v_exp_f32 v66, v66
v_add_u32 v28, v28, v29
v_exp_f32 v67, v67
v_cvt_pk_bf16_f32 v172, v64, v65
v_mfma_f32_32x32x16_bf16 a[32:47], a[24:27], v[168:171], a[32:47]
v_exp_f32 v68, v68
buffer_load_dword v13, v14, s[4:7], s31 offen sc1
v_exp_f32 v69, v69
v_cvt_pk_bf16_f32 v173, v66, v67
v_exp_f32 v70, v70
v_exp_f32 v71, v71
v_cvt_pk_bf16_f32 v174, v68, v69
v_mfma_f32_32x32x16_bf16 v[72:87], a[0:3], a[132:135], v[136:151]
v_exp_f32 v88, v88
v_exp_f32 v89, v89
v_cvt_pk_bf16_f32 v175, v70, v71
v_exp_f32 v90, v90
v_exp_f32 v91, v91
v_cvt_pk_bf16_f32 v176, v88, v89
v_mfma_f32_32x32x16_bf16 a[32:47], a[28:31], v[172:175], a[32:47]
v_exp_f32 v92, v92
v_exp_f32 v93, v93
v_cvt_pk_bf16_f32 v177, v90, v91
v_exp_f32 v94, v94
v_exp_f32 v95, v95
v_cvt_pk_bf16_f32 v178, v92, v93
v_exp_f32 v96, v96
v_exp_f32 v97, v97
v_cvt_pk_bf16_f32 v179, v94, v95
v_exp_f32 v98, v98
v_exp_f32 v99, v99
v_cvt_pk_bf16_f32 v180, v96, v97
v_mfma_f32_32x32x16_bf16 a[48:63], a[24:27], v[176:179], a[48:63]
v_exp_f32 v100, v100
v_exp_f32 v101, v101
v_cvt_pk_bf16_f32 v181, v98, v99
v_exp_f32 v102, v102
v_exp_f32 v103, v103
v_cvt_pk_bf16_f32 v182, v100, v101
s_waitcnt lgkmcnt(0)
v_mfma_f32_32x32x16_bf16 v[56:71], a[4:7], a[128:131], v[136:151]
v_exp_f32 v40, v40
ds_read_b128 a[0:3], v27 offset:8192
v_exp_f32 v41, v41
v_cvt_pk_bf16_f32 v183, v102, v103
v_exp_f32 v42, v42
ds_read_b64_tr_b16 a[16:17], v28 offset:0
v_exp_f32 v43, v43
v_cvt_pk_bf16_f32 v168, v40, v41
v_mfma_f32_32x32x16_bf16 a[48:63], a[28:31], v[180:183], a[48:63]
v_exp_f32 v44, v44
ds_read_b64_tr_b16 a[18:19], v28 offset:256
v_exp_f32 v45, v45
v_cvt_pk_bf16_f32 v169, v42, v43
v_exp_f32 v46, v46
ds_read_b64_tr_b16 a[20:21], v28 offset:512
v_exp_f32 v47, v47
v_cvt_pk_bf16_f32 v170, v44, v45
v_exp_f32 v48, v48
ds_read_b64_tr_b16 a[22:23], v28 offset:768
v_exp_f32 v49, v49
v_cvt_pk_bf16_f32 v171, v46, v47
v_exp_f32 v50, v50
v_add_u32 v28, v28, v29
v_exp_f32 v51, v51
v_cvt_pk_bf16_f32 v172, v48, v49
v_mfma_f32_32x32x16_bf16 a[32:47], a[8:11], v[168:171], a[32:47]
v_exp_f32 v52, v52
s_waitcnt vmcnt(0)
s_mov_b32 s21, 20000
fl_18:
v_cmp_ne_u32 vcc, s17, v13
s_cbranch_vccz fok_17
s_sub_u32 s21, s21, 1
s_cmp_eq_u32 s21, 0
s_cbranch_scc1 fok_17
buffer_load_dword v13, v14, s[4:7], s31 offen sc1
s_waitcnt vmcnt(0)
s_branch fl_18
fok_17:
v_exp_f32 v53, v53
v_cvt_pk_bf16_f32 v173, v50, v51
v_exp_f32 v54, v54
s_add_u32 s69, s70, s45
buffer_load_dwordx4 a[64:67], v2, s[4:7], s69 offen offset:0 sc1
v_exp_f32 v55, v55
v_cvt_pk_bf16_f32 v174, v52, v53
v_mfma_f32_32x32x16_bf16 v[88:103], a[4:7], a[132:135], v[136:151]
v_exp_f32 v72, v72
buffer_load_dwordx4 a[68:71], v2, s[4:7], s69 offen offset:1024 sc1
v_exp_f32 v73, v73
v_cvt_pk_bf16_f32 v175, v54, v55
v_exp_f32 v74, v74
buffer_load_dwordx4 a[72:75], v2, s[4:7], s69 offen offset:2048 sc1
v_exp_f32 v75, v75
v_cvt_pk_bf16_f32 v176, v72, v73
v_mfma_f32_32x32x16_bf16 a[32:47], a[12:15], v[172:175], a[32:47]
v_exp_f32 v76, v76
buffer_load_dwordx4 a[76:79], v2, s[4:7], s69 offen offset:3072 sc1
v_exp_f32 v77, v77
v_cvt_pk_bf16_f32 v177, v74, v75
v_exp_f32 v78, v78
s_add_u32 s69, s71, s45
buffer_load_dwordx4 a[80:83], v2, s[4:7], s69 offen offset:0 sc1
v_exp_f32 v79, v79
v_cvt_pk_bf16_f32 v178, v76, v77
v_exp_f32 v80, v80
buffer_load_dwordx4 a[84:87], v2, s[4:7], s69 offen offset:1024 sc1
v_exp_f32 v81, v81
v_cvt_pk_bf16_f32 v179, v78, v79
v_exp_f32 v82, v82
buffer_load_dwordx4 a[88:91], v2, s[4:7], s69 offen offset:2048 sc1
v_exp_f32 v83, v83
v_cvt_pk_bf16_f32 v180, v80, v81
v_mfma_f32_32x32x16_bf16 a[48:63], a[8:11], v[176:179], a[48:63]
v_exp_f32 v84, v84
buffer_load_dwordx4 a[92:95], v2, s[4:7], s69 offen offset:3072 sc1
v_exp_f32 v85, v85
v_cvt_pk_bf16_f32 v181, v82, v83
v_exp_f32 v86, v86
v_exp_f32 v87, v87
v_cvt_pk_bf16_f32 v182, v84, v85
s_cmp_lg_u32 s46, 8
s_cbranch_scc1 tv_19
v_mov_b32 v136, 0
v_mov_b32 v137, 0
v_mov_b32 v138, 0
v_mov_b32 v139, 0
v_mov_b32 v140, 0
v_mov_b32 v141, 0
v_mov_b32 v142, 0
v_mov_b32 v143, 0
v_mov_b32 v144, 0
v_mov_b32 v145, 0
v_mov_b32 v146, 0
v_mov_b32 v147, 0
v_mov_b32 v148, 0
v_mov_b32 v149, 0
v_mov_b32 v150, 0
v_mov_b32 v151, 0
tv_19:
s_waitcnt lgkmcnt(0)
v_mfma_f32_32x32x16_bf16 v[40:55], a[0:3], a[128:131], v[120:135]
v_exp_f32 v56, v56
ds_read_b128 a[4:7], v27 offset:9216
v_exp_f32 v57, v57
v_cvt_pk_bf16_f32 v183, v86, v87
v_exp_f32 v58, v58
ds_read_b64_tr_b16 a[24:25], v28 offset:0
v_exp_f32 v59, v59
v_cvt_pk_bf16_f32 v168, v56, v57
v_mfma_f32_32x32x16_bf16 a[48:63], a[12:15], v[180:183], a[48:63]
v_exp_f32 v60, v60
ds_read_b64_tr_b16 a[26:27], v28 offset:256
v_exp_f32 v61, v61
v_cvt_pk_bf16_f32 v169, v58, v59
v_exp_f32 v62, v62
ds_read_b64_tr_b16 a[28:29], v28 offset:512
v_exp_f32 v63, v63
v_cvt_pk_bf16_f32 v170, v60, v61
v_exp_f32 v64, v64
ds_read_b64_tr_b16 a[30:31], v28 offset:768
v_exp_f32 v65, v65
v_cvt_pk_bf16_f32 v171, v62, v63
v_exp_f32 v66, v66
v_add_u32 v28, v28, v29
v_exp_f32 v67, v67
v_cvt_pk_bf16_f32 v172, v64, v65
v_mfma_f32_32x32x16_bf16 a[32:47], a[16:19], v[168:171], a[32:47]
v_exp_f32 v68, v68
s_add_u32 s69, s72, s45
buffer_load_dwordx4 a[96:99], v2, s[4:7], s69 offen offset:0 sc1
v_exp_f32 v69, v69
v_cvt_pk_bf16_f32 v173, v66, v67
v_exp_f32 v70, v70
buffer_load_dwordx4 a[100:103], v2, s[4:7], s69 offen offset:1024 sc1
v_exp_f32 v71, v71
v_cvt_pk_bf16_f32 v174, v68, v69
v_mfma_f32_32x32x16_bf16 v[72:87], a[0:3], a[132:135], v[136:151]
v_exp_f32 v88, v88
buffer_load_dwordx4 a[104:107], v2, s[4:7], s69 offen offset:2048 sc1
v_exp_f32 v89, v89
v_cvt_pk_bf16_f32 v175, v70, v71
v_exp_f32 v90, v90
buffer_load_dwordx4 a[108:111], v2, s[4:7], s69 offen offset:3072 sc1
v_exp_f32 v91, v91
v_cvt_pk_bf16_f32 v176, v88, v89
v_mfma_f32_32x32x16_bf16 a[32:47], a[20:23], v[172:175], a[32:47]
v_exp_f32 v92, v92
s_add_u32 s69, s73, s45
buffer_load_dwordx4 a[112:115], v2, s[4:7], s69 offen offset:0 sc1
v_exp_f32 v93, v93
v_cvt_pk_bf16_f32 v177, v90, v91
v_exp_f32 v94, v94
buffer_load_dwordx4 a[116:119], v2, s[4:7], s69 offen offset:1024 sc1
v_exp_f32 v95, v95
v_cvt_pk_bf16_f32 v178, v92, v93
v_exp_f32 v96, v96
buffer_load_dwordx4 a[120:123], v2, s[4:7], s69 offen offset:2048 sc1
v_exp_f32 v97, v97
v_cvt_pk_bf16_f32 v179, v94, v95
v_exp_f32 v98, v98
buffer_load_dwordx4 a[124:127], v2, s[4:7], s69 offen offset:3072 sc1
v_exp_f32 v99, v99
v_cvt_pk_bf16_f32 v180, v96, v97
v_mfma_f32_32x32x16_bf16 a[48:63], a[16:19], v[176:179], a[48:63]
v_exp_f32 v100, v100
v_exp_f32 v101, v101
v_cvt_pk_bf16_f32 v181, v98, v99
v_exp_f32 v102, v102
v_exp_f32 v103, v103
v_cvt_pk_bf16_f32 v182, v100, v101
s_waitcnt lgkmcnt(0)
v_exp_f32 v40, v40
ds_read_b64_tr_b16 a[8:9], v28 offset:0
v_exp_f32 v41, v41
v_cvt_pk_bf16_f32 v183, v102, v103
v_exp_f32 v42, v42
ds_read_b64_tr_b16 a[10:11], v28 offset:256
v_exp_f32 v43, v43
v_cvt_pk_bf16_f32 v168, v40, v41
v_mfma_f32_32x32x16_bf16 a[48:63], a[20:23], v[180:183], a[48:63]
v_exp_f32 v44, v44
ds_read_b64_tr_b16 a[12:13], v28 offset:512
v_exp_f32 v45, v45
v_cvt_pk_bf16_f32 v169, v42, v43
v_exp_f32 v46, v46
ds_read_b64_tr_b16 a[14:15], v28 offset:768
v_exp_f32 v47, v47
v_cvt_pk_bf16_f32 v170, v44, v45
v_exp_f32 v48, v48
v_add_u32 v28, v28, v29
v_exp_f32 v49, v49
v_cvt_pk_bf16_f32 v171, v46, v47
v_exp_f32 v50, v50
s_add_u32 s69, s74, s45
buffer_load_dwordx4 a[136:139], v2, s[4:7], s69 offen offset:0 sc1
v_exp_f32 v51, v51
v_cvt_pk_bf16_f32 v172, v48, v49
v_mfma_f32_32x32x16_bf16 a[32:47], a[24:27], v[168:171], a[32:47]
v_exp_f32 v52, v52
buffer_load_dwordx4 a[140:143], v2, s[4:7], s69 offen offset:1024 sc1
v_exp_f32 v53, v53
v_cvt_pk_bf16_f32 v173, v50, v51
v_exp_f32 v54, v54
buffer_load_dwordx4 a[144:147], v2, s[4:7], s69 offen offset:2048 sc1
v_exp_f32 v55, v55
v_cvt_pk_bf16_f32 v174, v52, v53
v_mfma_f32_32x32x16_bf16 v[88:103], a[4:7], a[132:135], v[120:135]
v_exp_f32 v72, v72
buffer_load_dwordx4 a[148:151], v2, s[4:7], s69 offen offset:3072 sc1
v_exp_f32 v73, v73
v_cvt_pk_bf16_f32 v175, v54, v55
v_exp_f32 v74, v74
s_add_u32 s69, s75, s45
buffer_load_dwordx4 a[152:155], v2, s[4:7], s69 offen offset:0 sc1
v_exp_f32 v75, v75
v_cvt_pk_bf16_f32 v176, v72, v73
v_mfma_f32_32x32x16_bf16 a[32:47], a[28:31], v[172:175], a[32:47]
v_exp_f32 v76, v76
buffer_load_dwordx4 a[156:159], v2, s[4:7], s69 offen offset:1024 sc1
v_exp_f32 v77, v77
v_cvt_pk_bf16_f32 v177, v74, v75
v_exp_f32 v78, v78
buffer_load_dwordx4 a[160:163], v2, s[4:7], s69 offen offset:2048 sc1
v_exp_f32 v79, v79
v_cvt_pk_bf16_f32 v178, v76, v77
v_exp_f32 v80, v80
buffer_load_dwordx4 a[164:167], v2, s[4:7], s69 offen offset:3072 sc1
v_exp_f32 v81, v81
v_cvt_pk_bf16_f32 v179, v78, v79
v_exp_f32 v82, v82
v_exp_f32 v83, v83
v_cvt_pk_bf16_f32 v180, v80, v81
v_mfma_f32_32x32x16_bf16 a[48:63], a[24:27], v[176:179], a[48:63]
v_exp_f32 v84, v84
v_exp_f32 v85, v85
v_cvt_pk_bf16_f32 v181, v82, v83
v_exp_f32 v86, v86
v_exp_f32 v87, v87
v_cvt_pk_bf16_f32 v182, v84, v85
v_cvt_pk_bf16_f32 v183, v86, v87
s_nop 1
v_mfma_f32_32x32x16_bf16 a[48:63], a[28:31], v[180:183], a[48:63]
v_exp_f32 v88, v88
s_add_u32 s69, s76, s45
buffer_load_dwordx4 a[168:171], v2, s[4:7], s69 offen offset:0 sc1
v_exp_f32 v89, v89
v_exp_f32 v90, v90
buffer_load_dwordx4 a[172:175], v2, s[4:7], s69 offen offset:1024 sc1
v_exp_f32 v91, v91
v_cvt_pk_bf16_f32 v176, v88, v89
v_exp_f32 v92, v92
buffer_load_dwordx4 a[176:179], v2, s[4:7], s69 offen offset:2048 sc1
v_exp_f32 v93, v93
v_cvt_pk_bf16_f32 v177, v90, v91
v_exp_f32 v94, v94
buffer_load_dwordx4 a[180:183], v2, s[4:7], s69 offen offset:3072 sc1
v_exp_f32 v95, v95
v_cvt_pk_bf16_f32 v178, v92, v93
v_exp_f32 v96, v96
v_exp_f32 v97, v97
v_cvt_pk_bf16_f32 v179, v94, v95
v_exp_f32 v98, v98
v_exp_f32 v99, v99
v_cvt_pk_bf16_f32 v180, v96, v97
v_mfma_f32_32x32x16_bf16 a[48:63], a[8:11], v[176:179], a[48:63]
v_exp_f32 v100, v100
v_exp_f32 v101, v101
v_cvt_pk_bf16_f32 v181, v98, v99
v_exp_f32 v102, v102
v_exp_f32 v103, v103
v_cvt_pk_bf16_f32 v182, v100, v101
v_cvt_pk_bf16_f32 v183, v102, v103
s_nop 1
v_mfma_f32_32x32x16_bf16 a[48:63], a[12:15], v[180:183], a[48:63]
v_accvgpr_read_b32 v32, a40
s_nop 10
v_accvgpr_read_b32 v33, a56
s_mov_b32 s20, 0x2b800000
s_mov_b32 s21, 0x53800000
v_cmp_le_f32 s[22:23], s20, v32
v_cmp_ge_f32 s[24:25], s21, v32
v_cmp_le_f32 s[26:27], s20, v33
v_cmp_ge_f32 vcc, s21, v33
s_and_b64 s[22:23], s[22:23], s[24:25]
s_and_b64 s[26:27], s[26:27], vcc
s_and_b64 s[22:23], s[22:23], s[26:27]
s_cmp_eq_u64 s[22:23], -1
s_cbranch_scc0 fallback_20
fbret_21:
s_lshl_b32 s21, s47, 15
s_lshl_b32 s22, s28, 10
s_add_u32 s21, s21, s22
s_add_u32 s21, s21, 0xd00000
s_add_u32 s22, s21, 32768
v_accvgpr_read_b32 v32, a40
v_rcp_f32 v32, v32
v_accvgpr_read_b32 v40, a32
v_mul_f32 v40, v32, v40
v_accvgpr_read_b32 v41, a33
v_mul_f32 v41, v32, v41
v_accvgpr_read_b32 v42, a34
v_mul_f32 v42, v32, v42
v_accvgpr_read_b32 v43, a35
v_mul_f32 v43, v32, v43
v_accvgpr_read_b32 v44, a36
v_mul_f32 v44, v32, v44
v_accvgpr_read_b32 v45, a37
v_mul_f32 v45, v32, v45
v_accvgpr_read_b32 v46, a38
v_mul_f32 v46, v32, v46
v_accvgpr_read_b32 v47, a39
v_mul_f32 v47, v32, v47
v_cvt_pk_bf16_f32 v168, v40, v41
v_cvt_pk_bf16_f32 v169, v42, v43
v_cvt_pk_bf16_f32 v170, v44, v45
v_cvt_pk_bf16_f32 v171, v46, v47
buffer_store_dwordx4 v[168:171], v2, s[4:7], s21 offen sc1
v_accvgpr_read_b32 v32, a56
v_rcp_f32 v32, v32
v_accvgpr_read_b32 v40, a48
v_mul_f32 v40, v32, v40
v_accvgpr_read_b32 v41, a49
v_mul_f32 v41, v32, v41
v_accvgpr_read_b32 v42, a50
v_mul_f32 v42, v32, v42
v_accvgpr_read_b32 v43, a51
v_mul_f32 v43, v32, v43
v_accvgpr_read_b32 v44, a52
v_mul_f32 v44, v32, v44
v_accvgpr_read_b32 v45, a53
v_mul_f32 v45, v32, v45
v_accvgpr_read_b32 v46, a54
v_mul_f32 v46, v32, v46
v_accvgpr_read_b32 v47, a55
v_mul_f32 v47, v32, v47
v_cvt_pk_bf16_f32 v176, v40, v41
v_cvt_pk_bf16_f32 v177, v42, v43
v_cvt_pk_bf16_f32 v178, v44, v45
v_cvt_pk_bf16_f32 v179, v46, v47
buffer_store_dwordx4 v[176:179], v2, s[4:7], s22 offen sc1
s_mov_b32 s56, s14
s_mov_b32 s57, s15
s_mov_b32 s58, 0x200000
s_mov_b32 s59, 0x20000
v_bfe_u32 v30, v1, 2, 2
v_lshrrev_b32 v29, 5, v1
v_lshlrev_b32 v29, 2, v29
v_add_u32 v29, v29, v30
v_lshlrev_b32 v29, 7, v29
v_bfe_u32 v31, v1, 4, 1
v_lshlrev_b32 v31, 5, v31
v_add_u32 v29, v29, v31
v_and_b32 v31, 3, v1
v_lshlrev_b32 v31, 3, v31
v_add_u32 v29, v29, v31
s_lshl_b32 s22, s51, 13
v_add_u32 v29, s22, v29
v_lshrrev_b32 v30, 1, v30
s_xor_b32 s22, s51, 0
v_xor_b32 v31, s22, v30
v_lshlrev_b32 v31, 6, v31
v_add_u32 v7, v29, v31
v_add_u32 v9, 65536, v7
v_add_u32 v11, 131072, v7
s_xor_b32 s22, s51, 1
v_xor_b32 v31, s22, v30
v_lshlrev_b32 v31, 6, v31
v_add_u32 v8, v29, v31
v_add_u32 v10, 65536, v8
v_add_u32 v12, 131072, v8
s_waitcnt vmcnt(29)
s_barrier
s_lshl_b32 s20, s48, 1
s_add_u32 s20, s20, s50
s_lshl_b32 s20, s20, 9
s_add_u32 s20, s20, 0xf00000
v_and_b32 v28, 31, v1
v_lshlrev_b32 v28, 4, v28
buffer_load_dword v24, v28, s[4:7], s20 offen offset:8 sc1
s_lshl_b32 s20, s16, 12
v_add_u32 v141, s20, v2
s_xor_b32 s21, s16, 2
s_lshl_b32 s21, s21, 12
v_add_u32 v142, s21, v2
ds_read_b64_tr_b16 v[48:49], v7 offset:0
ds_read_b64_tr_b16 v[50:51], v7 offset:1024
ds_read_b64_tr_b16 v[52:53], v8 offset:0
ds_read_b64_tr_b16 v[54:55], v8 offset:1024
ds_read_b64_tr_b16 v[56:57], v7 offset:2048
ds_read_b64_tr_b16 v[58:59], v7 offset:3072
ds_read_b64_tr_b16 v[60:61], v8 offset:2048
ds_read_b64_tr_b16 v[62:63], v8 offset:3072
s_waitcnt lgkmcnt(6)
v_mfma_f32_32x32x16_bf16 v[72:87], v[48:51], a[64:67], 0
ds_read_b64_tr_b16 v[64:65], v7 offset:4096
ds_read_b64_tr_b16 v[66:67], v7 offset:5120
s_lshl4_add_u32 s68, s77, s53
s_add_u32 m0, s52, 114688
s_nop 0
buffer_load_dwordx4 v3, s[32:35], s68 offen offset:0 lds
s_waitcnt lgkmcnt(6)
v_mfma_f32_32x32x16_bf16 v[88:103], v[52:55], a[64:67], 0
ds_read_b64_tr_b16 v[68:69], v8 offset:4096
ds_read_b64_tr_b16 v[70:71], v8 offset:5120
s_add_u32 s69, s77, s45
buffer_load_dwordx4 a[184:187], v2, s[4:7], s69 offen offset:0 sc1
s_waitcnt lgkmcnt(6)
s_waitcnt vmcnt(31)
v_mfma_f32_32x32x16_bf16 v[72:87], v[56:59], a[68:71], v[72:87]
ds_read_b64_tr_b16 v[48:49], v7 offset:6144
ds_read_b64_tr_b16 v[50:51], v7 offset:7168
buffer_load_dwordx4 v4, s[32:35], s68 offen offset:1024 lds
s_waitcnt lgkmcnt(6)
v_mfma_f32_32x32x16_bf16 v[88:103], v[60:63], a[68:71], v[88:103]
ds_read_b64_tr_b16 v[52:53], v8 offset:6144
ds_read_b64_tr_b16 v[54:55], v8 offset:7168
buffer_load_dwordx4 a[188:191], v2, s[4:7], s69 offen offset:1024 sc1
s_waitcnt lgkmcnt(6)
s_waitcnt vmcnt(32)
v_mfma_f32_32x32x16_bf16 v[72:87], v[64:67], a[72:75], v[72:87]
s_barrier
ds_read_b64_tr_b16 v[56:57], v7 offset:16384
ds_read_b64_tr_b16 v[58:59], v7 offset:17408
buffer_load_dwordx4 v5, s[32:35], s68 offen offset:2048 lds
s_waitcnt lgkmcnt(6)
v_mfma_f32_32x32x16_bf16 v[88:103], v[68:71], a[72:75], v[88:103]
ds_read_b64_tr_b16 v[60:61], v8 offset:16384
ds_read_b64_tr_b16 v[62:63], v8 offset:17408
buffer_load_dwordx4 a[192:195], v2, s[4:7], s69 offen offset:2048 sc1
s_waitcnt lgkmcnt(6)
s_waitcnt vmcnt(33)
v_mfma_f32_32x32x16_bf16 v[72:87], v[48:51], a[76:79], v[72:87]
ds_read_b64_tr_b16 v[64:65], v7 offset:18432
ds_read_b64_tr_b16 v[66:67], v7 offset:19456
buffer_load_dwordx4 v6, s[32:35], s68 offen offset:3072 lds
s_waitcnt lgkmcnt(6)
v_mfma_f32_32x32x16_bf16 v[88:103], v[52:55], a[76:79], v[88:103]
ds_read_b64_tr_b16 v[68:69], v8 offset:18432
ds_read_b64_tr_b16 v[70:71], v8 offset:19456
buffer_load_dwordx4 a[196:199], v2, s[4:7], s69 offen offset:3072 sc1
s_waitcnt lgkmcnt(6)
s_waitcnt vmcnt(34)
v_mfma_f32_32x32x16_bf16 v[72:87], v[56:59], a[80:83], v[72:87]
ds_read_b64_tr_b16 v[48:49], v7 offset:20480
ds_read_b64_tr_b16 v[50:51], v7 offset:21504
s_lshl4_add_u32 s68, s78, s53
s_add_u32 m0, s52, 131072
s_nop 0
buffer_load_dwordx4 v3, s[32:35], s68 offen offset:0 lds
s_waitcnt lgkmcnt(6)
v_mfma_f32_32x32x16_bf16 v[88:103], v[60:63], a[80:83], v[88:103]
ds_read_b64_tr_b16 v[52:53], v8 offset:20480
ds_read_b64_tr_b16 v[54:55], v8 offset:21504
s_add_u32 s69, s78, s45
buffer_load_dwordx4 a[200:203], v2, s[4:7], s69 offen offset:0 sc1
s_waitcnt lgkmcnt(6)
s_waitcnt vmcnt(35)
v_mfma_f32_32x32x16_bf16 v[72:87], v[64:67], a[84:87], v[72:87]
ds_read_b64_tr_b16 v[56:57], v7 offset:22528
ds_read_b64_tr_b16 v[58:59], v7 offset:23552
buffer_load_dwordx4 v4, s[32:35], s68 offen offset:1024 lds
s_waitcnt lgkmcnt(6)
v_mfma_f32_32x32x16_bf16 v[88:103], v[68:71], a[84:87], v[88:103]
ds_read_b64_tr_b16 v[60:61], v8 offset:22528
ds_read_b64_tr_b16 v[62:63], v8 offset:23552
buffer_load_dwordx4 a[204:207], v2, s[4:7], s69 offen offset:1024 sc1
s_waitcnt lgkmcnt(6)
s_waitcnt vmcnt(36)
v_mfma_f32_32x32x16_bf16 v[72:87], v[48:51], a[88:91], v[72:87]
s_cmp_lg_u32 s2, 0
s_cbranch_scc1 ep1_22
s_cmp_lg_u32 s16, 0
s_cbranch_scc1 ep1_22
v_lshrrev_b32 v28, 2, v1
v_lshlrev_b32 v28, 8, v28
v_and_b32 v29, 3, v1
v_lshlrev_b32 v29, 4, v29
v_add_u32 v140, v28, v29
s_mov_b32 s20, 0xf10000
buffer_load_dwordx4 v[136:139], v140, s[4:7], s20 offen sc1
ep1_22:
ds_read_b64_tr_b16 v[64:65], v7 offset:32768
ds_read_b64_tr_b16 v[66:67], v7 offset:33792
buffer_load_dwordx4 v5, s[32:35], s68 offen offset:2048 lds
s_waitcnt lgkmcnt(6)
v_mfma_f32_32x32x16_bf16 v[88:103], v[52:55], a[88:91], v[88:103]
ds_read_b64_tr_b16 v[68:69], v8 offset:32768
ds_read_b64_tr_b16 v[70:71], v8 offset:33792
buffer_load_dwordx4 a[208:211], v2, s[4:7], s69 offen offset:2048 sc1
s_waitcnt lgkmcnt(6)
s_waitcnt vmcnt(37)
v_mfma_f32_32x32x16_bf16 v[72:87], v[56:59], a[92:95], v[72:87]
ds_read_b64_tr_b16 v[48:49], v7 offset:34816
ds_read_b64_tr_b16 v[50:51], v7 offset:35840
buffer_load_dwordx4 v6, s[32:35], s68 offen offset:3072 lds
s_waitcnt lgkmcnt(6)
v_mfma_f32_32x32x16_bf16 v[88:103], v[60:63], a[92:95], v[88:103]
ds_read_b64_tr_b16 v[52:53], v8 offset:34816
ds_read_b64_tr_b16 v[54:55], v8 offset:35840
buffer_load_dwordx4 a[212:215], v2, s[4:7], s69 offen offset:3072 sc1
s_waitcnt lgkmcnt(6)
s_waitcnt vmcnt(38)
v_mfma_f32_32x32x16_bf16 v[72:87], v[64:67], a[96:99], v[72:87]
ds_read_b64_tr_b16 v[56:57], v7 offset:36864
ds_read_b64_tr_b16 v[58:59], v7 offset:37888
s_lshl4_add_u32 s68, s79, s53
s_add_u32 m0, s52, 147456
s_nop 0
buffer_load_dwordx4 v3, s[32:35], s68 offen offset:0 lds
s_waitcnt lgkmcnt(6)
v_mfma_f32_32x32x16_bf16 v[88:103], v[68:71], a[96:99], v[88:103]
ds_read_b64_tr_b16 v[60:61], v8 offset:36864
ds_read_b64_tr_b16 v[62:63], v8 offset:37888
s_add_u32 s69, s79, s45
buffer_load_dwordx4 a[216:219], v2, s[4:7], s69 offen offset:0 sc1
s_waitcnt lgkmcnt(6)
s_waitcnt vmcnt(39)
v_mfma_f32_32x32x16_bf16 v[72:87], v[48:51], a[100:103], v[72:87]
ds_read_b64_tr_b16 v[64:65], v7 offset:38912
ds_read_b64_tr_b16 v[66:67], v7 offset:39936
buffer_load_dwordx4 v4, s[32:35], s68 offen offset:1024 lds
s_waitcnt lgkmcnt(6)
v_mfma_f32_32x32x16_bf16 v[88:103], v[52:55], a[100:103], v[88:103]
ds_read_b64_tr_b16 v[68:69], v8 offset:38912
ds_read_b64_tr_b16 v[70:71], v8 offset:39936
buffer_load_dwordx4 a[220:223], v2, s[4:7], s69 offen offset:1024 sc1
s_waitcnt lgkmcnt(6)
s_waitcnt vmcnt(40)
v_mfma_f32_32x32x16_bf16 v[72:87], v[56:59], a[104:107], v[72:87]
s_waitcnt vmcnt(21)
s_barrier
s_lshl_b32 s20, s29, 8
s_lshl_b32 s21, s28, 2
s_add_u32 s20, s20, s21
s_add_u32 s20, s20, 0xf14000
s_cmp_lg_u32 s16, 0
s_cbranch_scc1 nofl_23
v_mov_b32 v28, s17
v_mov_b32 v29, 0
s_mov_b64 exec, 1
buffer_store_dword v28, v29, s[4:7], s20 offen sc1
s_mov_b64 exec, -1
nofl_23:
ds_read_b64_tr_b16 v[48:49], v7 offset:49152
ds_read_b64_tr_b16 v[50:51], v7 offset:50176
buffer_load_dwordx4 v5, s[32:35], s68 offen offset:2048 lds
s_waitcnt lgkmcnt(6)
v_mfma_f32_32x32x16_bf16 v[88:103], v[60:63], a[104:107], v[88:103]
ds_read_b64_tr_b16 v[52:53], v8 offset:49152
ds_read_b64_tr_b16 v[54:55], v8 offset:50176
buffer_load_dwordx4 a[224:227], v2, s[4:7], s69 offen offset:2048 sc1
s_waitcnt lgkmcnt(6)
v_mfma_f32_32x32x16_bf16 v[72:87], v[64:67], a[108:111], v[72:87]
ds_read_b64_tr_b16 v[56:57], v7 offset:51200
ds_read_b64_tr_b16 v[58:59], v7 offset:52224
buffer_load_dwordx4 v6, s[32:35], s68 offen offset:3072 lds
s_waitcnt lgkmcnt(6)
v_mfma_f32_32x32x16_bf16 v[88:103], v[68:71], a[108:111], v[88:103]
ds_read_b64_tr_b16 v[60:61], v8 offset:51200
ds_read_b64_tr_b16 v[62:63], v8 offset:52224
buffer_load_dwordx4 a[228:231], v2, s[4:7], s69 offen offset:3072 sc1
s_waitcnt lgkmcnt(6)
v_mfma_f32_32x32x16_bf16 v[72:87], v[48:51], a[112:115], v[72:87]
ds_read_b64_tr_b16 v[64:65], v7 offset:53248
ds_read_b64_tr_b16 v[66:67], v7 offset:54272
s_lshl4_add_u32 s68, s80, s53
s_add_u32 m0, s52, 0
s_nop 0
buffer_load_dwordx4 v3, s[32:35], s68 offen offset:0 lds
s_waitcnt lgkmcnt(6)
v_mfma_f32_32x32x16_bf16 v[88:103], v[52:55], a[112:115], v[88:103]
ds_read_b64_tr_b16 v[68:69], v8 offset:53248
ds_read_b64_tr_b16 v[70:71], v8 offset:54272
s_add_u32 s69, s80, s45
buffer_load_dwordx4 a[232:235], v2, s[4:7], s69 offen offset:0 sc1
s_waitcnt lgkmcnt(6)
v_mfma_f32_32x32x16_bf16 v[72:87], v[56:59], a[116:119], v[72:87]
ds_read_b64_tr_b16 v[48:49], v7 offset:55296
ds_read_b64_tr_b16 v[50:51], v7 offset:56320
buffer_load_dwordx4 v4, s[32:35], s68 offen offset:1024 lds
s_waitcnt lgkmcnt(6)
v_mfma_f32_32x32x16_bf16 v[88:103], v[60:63], a[116:119], v[88:103]
ds_read_b64_tr_b16 v[52:53], v8 offset:55296
ds_read_b64_tr_b16 v[54:55], v8 offset:56320
buffer_load_dwordx4 a[236:239], v2, s[4:7], s69 offen offset:1024 sc1
s_waitcnt lgkmcnt(6)
v_mfma_f32_32x32x16_bf16 v[72:87], v[64:67], a[120:123], v[72:87]
ds_read_b64_tr_b16 v[56:57], v9 offset:0
ds_read_b64_tr_b16 v[58:59], v9 offset:1024
buffer_load_dwordx4 v5, s[32:35], s68 offen offset:2048 lds
s_waitcnt lgkmcnt(6)
v_mfma_f32_32x32x16_bf16 v[88:103], v[68:71], a[120:123], v[88:103]
ds_read_b64_tr_b16 v[60:61], v10 offset:0
ds_read_b64_tr_b16 v[62:63], v10 offset:1024
s_waitcnt lgkmcnt(6)
v_mfma_f32_32x32x16_bf16 v[72:87], v[48:51], a[124:127], v[72:87]
ds_read_b64_tr_b16 v[64:65], v9 offset:2048
ds_read_b64_tr_b16 v[66:67], v9 offset:3072
buffer_load_dwordx4 v6, s[32:35], s68 offen offset:3072 lds
s_waitcnt lgkmcnt(6)
v_mfma_f32_32x32x16_bf16 v[88:103], v[52:55], a[124:127], v[88:103]
ds_read_b64_tr_b16 v[68:69], v10 offset:2048
ds_read_b64_tr_b16 v[70:71], v10 offset:3072
buffer_load_dwordx4 a[240:243], v2, s[4:7], s69 offen offset:2048 sc1
s_waitcnt lgkmcnt(6)
v_mfma_f32_32x32x16_bf16 v[72:87], v[56:59], a[136:139], v[72:87]
ds_read_b64_tr_b16 v[48:49], v9 offset:4096
ds_read_b64_tr_b16 v[50:51], v9 offset:5120
s_lshl4_add_u32 s68, s81, s53
s_add_u32 m0, s52, 16384
s_nop 0
buffer_load_dwordx4 v3, s[32:35], s68 offen offset:0 lds
s_waitcnt lgkmcnt(6)
v_mfma_f32_32x32x16_bf16 v[88:103], v[60:63], a[136:139], v[88:103]
ds_read_b64_tr_b16 v[52:53], v10 offset:4096
ds_read_b64_tr_b16 v[54:55], v10 offset:5120
buffer_load_dwordx4 a[244:247], v2, s[4:7], s69 offen offset:3072 sc1
s_waitcnt lgkmcnt(6)
v_mfma_f32_32x32x16_bf16 v[72:87], v[64:67], a[140:143], v[72:87]
ds_read_b64_tr_b16 v[56:57], v9 offset:6144
ds_read_b64_tr_b16 v[58:59], v9 offset:7168
buffer_load_dwordx4 v4, s[32:35], s68 offen offset:1024 lds
s_waitcnt lgkmcnt(6)
v_mfma_f32_32x32x16_bf16 v[88:103], v[68:71], a[140:143], v[88:103]
ds_read_b64_tr_b16 v[60:61], v10 offset:6144
ds_read_b64_tr_b16 v[62:63], v10 offset:7168
s_add_u32 s69, s81, s45
buffer_load_dwordx4 a[248:251], v2, s[4:7], s69 offen offset:0 sc1
s_waitcnt lgkmcnt(6)
v_mfma_f32_32x32x16_bf16 v[72:87], v[48:51], a[144:147], v[72:87]
s_barrier
ds_read_b64_tr_b16 v[64:65], v9 offset:16384
ds_read_b64_tr_b16 v[66:67], v9 offset:17408
buffer_load_dwordx4 v5, s[32:35], s68 offen offset:2048 lds
s_waitcnt lgkmcnt(6)
v_mfma_f32_32x32x16_bf16 v[88:103], v[52:55], a[144:147], v[88:103]
ds_read_b64_tr_b16 v[68:69], v10 offset:16384
ds_read_b64_tr_b16 v[70:71], v10 offset:17408
buffer_load_dwordx4 a[252:255], v2, s[4:7], s69 offen offset:1024 sc1
s_waitcnt lgkmcnt(6)
v_mfma_f32_32x32x16_bf16 v[72:87], v[56:59], a[148:151], v[72:87]
ds_read_b64_tr_b16 v[48:49], v9 offset:18432
ds_read_b64_tr_b16 v[50:51], v9 offset:19456
buffer_load_dwordx4 v6, s[32:35], s68 offen offset:3072 lds
s_waitcnt lgkmcnt(6)
v_mfma_f32_32x32x16_bf16 v[88:103], v[60:63], a[148:151], v[88:103]
ds_read_b64_tr_b16 v[52:53], v10 offset:18432
ds_read_b64_tr_b16 v[54:55], v10 offset:19456
buffer_load_dwordx4 a[64:67], v2, s[4:7], s69 offen offset:2048 sc1
s_waitcnt lgkmcnt(6)
v_mfma_f32_32x32x16_bf16 v[72:87], v[64:67], a[152:155], v[72:87]
ds_read_b64_tr_b16 v[56:57], v9 offset:20480
ds_read_b64_tr_b16 v[58:59], v9 offset:21504
s_lshl4_add_u32 s68, s82, s53
s_add_u32 m0, s52, 32768
s_nop 0
buffer_load_dwordx4 v3, s[32:35], s68 offen offset:0 lds
s_waitcnt lgkmcnt(6)
v_mfma_f32_32x32x16_bf16 v[88:103], v[68:71], a[152:155], v[88:103]
ds_read_b64_tr_b16 v[60:61], v10 offset:20480
ds_read_b64_tr_b16 v[62:63], v10 offset:21504
buffer_load_dwordx4 a[68:71], v2, s[4:7], s69 offen offset:3072 sc1
s_waitcnt lgkmcnt(6)
v_mfma_f32_32x32x16_bf16 v[72:87], v[48:51], a[156:159], v[72:87]
ds_read_b64_tr_b16 v[64:65], v9 offset:22528
ds_read_b64_tr_b16 v[66:67], v9 offset:23552
buffer_load_dwordx4 v4, s[32:35], s68 offen offset:1024 lds
s_waitcnt lgkmcnt(6)
v_mfma_f32_32x32x16_bf16 v[88:103], v[52:55], a[156:159], v[88:103]
ds_read_b64_tr_b16 v[68:69], v10 offset:22528
ds_read_b64_tr_b16 v[70:71], v10 offset:23552
s_add_u32 s69, s82, s45
buffer_load_dwordx4 a[72:75], v2, s[4:7], s69 offen offset:0 sc1
s_waitcnt lgkmcnt(6)
v_mfma_f32_32x32x16_bf16 v[72:87], v[56:59], a[160:163], v[72:87]
ds_read_b64_tr_b16 v[48:49], v9 offset:32768
ds_read_b64_tr_b16 v[50:51], v9 offset:33792
buffer_load_dwordx4 v5, s[32:35], s68 offen offset:2048 lds
s_waitcnt lgkmcnt(6)
v_mfma_f32_32x32x16_bf16 v[88:103], v[60:63], a[160:163], v[88:103]
ds_read_b64_tr_b16 v[52:53], v10 offset:32768
ds_read_b64_tr_b16 v[54:55], v10 offset:33792
buffer_load_dwordx4 a[76:79], v2, s[4:7], s69 offen offset:1024 sc1
s_waitcnt lgkmcnt(6)
v_mfma_f32_32x32x16_bf16 v[72:87], v[64:67], a[164:167], v[72:87]
ds_read_b64_tr_b16 v[56:57], v9 offset:34816
ds_read_b64_tr_b16 v[58:59], v9 offset:35840
buffer_load_dwordx4 v6, s[32:35], s68 offen offset:3072 lds
s_waitcnt lgkmcnt(6)
v_mfma_f32_32x32x16_bf16 v[88:103], v[68:71], a[164:167], v[88:103]
ds_read_b64_tr_b16 v[60:61], v10 offset:34816
ds_read_b64_tr_b16 v[62:63], v10 offset:35840
buffer_load_dwordx4 a[80:83], v2, s[4:7], s69 offen offset:2048 sc1
s_waitcnt lgkmcnt(6)
v_mfma_f32_32x32x16_bf16 v[72:87], v[48:51], a[168:171], v[72:87]
ds_read_b64_tr_b16 v[64:65], v9 offset:36864
ds_read_b64_tr_b16 v[66:67], v9 offset:37888
s_lshl4_add_u32 s68, s83, s53
s_add_u32 m0, s52, 49152
s_nop 0
buffer_load_dwordx4 v3, s[32:35], s68 offen offset:0 lds
s_waitcnt lgkmcnt(6)
v_mfma_f32_32x32x16_bf16 v[88:103], v[52:55], a[168:171], v[88:103]
ds_read_b64_tr_b16 v[68:69], v10 offset:36864
ds_read_b64_tr_b16 v[70:71], v10 offset:37888
buffer_load_dwordx4 a[84:87], v2, s[4:7], s69 offen offset:3072 sc1
s_waitcnt lgkmcnt(6)
v_mfma_f32_32x32x16_bf16 v[72:87], v[56:59], a[172:175], v[72:87]
ds_read_b64_tr_b16 v[48:49], v9 offset:38912
ds_read_b64_tr_b16 v[50:51], v9 offset:39936
buffer_load_dwordx4 v4, s[32:35], s68 offen offset:1024 lds
s_waitcnt lgkmcnt(6)
v_mfma_f32_32x32x16_bf16 v[88:103], v[60:63], a[172:175], v[88:103]
ds_read_b64_tr_b16 v[52:53], v10 offset:38912
ds_read_b64_tr_b16 v[54:55], v10 offset:39936
s_add_u32 s69, s83, s45
buffer_load_dwordx4 a[88:91], v2, s[4:7], s69 offen offset:0 sc1
s_waitcnt lgkmcnt(6)
v_mfma_f32_32x32x16_bf16 v[72:87], v[64:67], a[176:179], v[72:87]
s_waitcnt vmcnt(44)
s_waitcnt vmcnt(36)
s_barrier
s_lshr_b32 s20, s48, 2
s_lshl_b32 s20, s20, 8
s_add_u32 s31, s20, 0xf14000
v_and_b32 v14, 31, v1
v_lshlrev_b32 v14, 2, v14
buffer_load_dword v13, v14, s[4:7], s31 offen sc1
ds_read_b64_tr_b16 v[56:57], v9 offset:49152
ds_read_b64_tr_b16 v[58:59], v9 offset:50176
buffer_load_dwordx4 v5, s[32:35], s68 offen offset:2048 lds
s_waitcnt lgkmcnt(6)
v_mfma_f32_32x32x16_bf16 v[88:103], v[68:71], a[176:179], v[88:103]
ds_read_b64_tr_b16 v[60:61], v10 offset:49152
ds_read_b64_tr_b16 v[62:63], v10 offset:50176
buffer_load_dwordx4 a[92:95], v2, s[4:7], s69 offen offset:1024 sc1
s_waitcnt lgkmcnt(6)
v_mfma_f32_32x32x16_bf16 v[72:87], v[48:51], a[180:183], v[72:87]
ds_read_b64_tr_b16 v[64:65], v9 offset:51200
ds_read_b64_tr_b16 v[66:67], v9 offset:52224
buffer_load_dwordx4 v6, s[32:35], s68 offen offset:3072 lds
s_waitcnt lgkmcnt(6)
v_mfma_f32_32x32x16_bf16 v[88:103], v[52:55], a[180:183], v[88:103]
ds_read_b64_tr_b16 v[68:69], v10 offset:51200
ds_read_b64_tr_b16 v[70:71], v10 offset:52224
buffer_load_dwordx4 a[96:99], v2, s[4:7], s69 offen offset:2048 sc1
s_waitcnt lgkmcnt(6)
v_mfma_f32_32x32x16_bf16 v[72:87], v[56:59], a[184:187], v[72:87]
ds_read_b64_tr_b16 v[48:49], v9 offset:53248
ds_read_b64_tr_b16 v[50:51], v9 offset:54272
s_add_u32 s68, s44, 0
s_add_u32 m0, s52, 65536
s_nop 0
buffer_load_dwordx4 v3, s[36:39], s68 offen offset:0 lds
s_waitcnt lgkmcnt(6)
v_mfma_f32_32x32x16_bf16 v[88:103], v[60:63], a[184:187], v[88:103]
ds_read_b64_tr_b16 v[52:53], v10 offset:53248
ds_read_b64_tr_b16 v[54:55], v10 offset:54272
buffer_load_dwordx4 a[100:103], v2, s[4:7], s69 offen offset:3072 sc1
s_waitcnt lgkmcnt(6)
v_mfma_f32_32x32x16_bf16 v[72:87], v[64:67], a[188:191], v[72:87]
ds_read_b64_tr_b16 v[56:57], v9 offset:55296
ds_read_b64_tr_b16 v[58:59], v9 offset:56320
buffer_load_dwordx4 v4, s[36:39], s68 offen offset:1024 lds
s_waitcnt lgkmcnt(6)
v_mfma_f32_32x32x16_bf16 v[88:103], v[68:71], a[188:191], v[88:103]
ds_read_b64_tr_b16 v[60:61], v10 offset:55296
ds_read_b64_tr_b16 v[62:63], v10 offset:56320
s_waitcnt lgkmcnt(6)
v_mfma_f32_32x32x16_bf16 v[72:87], v[48:51], a[192:195], v[72:87]
s_cmp_lg_u32 s2, 0
s_cbranch_scc1 ep2_24
s_cmp_lg_u32 s16, 0
s_cbranch_scc1 ep2_24
s_mov_b32 s20, 0xf10000
s_mov_b32 s23, 20000
epl_25:
v_xor_b32 v136, s17, v136
v_xor_b32 v137, s17, v137
v_xor_b32 v138, s17, v138
v_xor_b32 v139, s17, v139
v_or_b32 v136, v136, v137
v_or_b32 v138, v138, v139
v_or_b32 v136, v136, v138
v_cmp_ne_u32 vcc, 0, v136
s_cbranch_vccz epg_26
s_sub_u32 s23, s23, 1
s_cmp_eq_u32 s23, 0
s_cbranch_scc1 ep2_24
buffer_load_dwordx4 v[136:139], v140, s[4:7], s20 offen sc1
s_waitcnt vmcnt(0)
s_branch epl_25
epg_26:
v_mov_b32 v136, s17
v_mov_b32 v137, 0
s_mov_b32 s20, 0xf19000
s_mov_b64 exec, 1
buffer_store_dword v136, v137, s[4:7], s20 offen sc1
s_mov_b64 exec, -1
ep2_24:
ds_read_b64_tr_b16 v[64:65], v11 offset:0
ds_read_b64_tr_b16 v[66:67], v11 offset:1024
buffer_load_dwordx4 v5, s[36:39], s68 offen offset:2048 lds
s_waitcnt lgkmcnt(6)
v_mfma_f32_32x32x16_bf16 v[88:103], v[52:55], a[192:195], v[88:103]
ds_read_b64_tr_b16 v[68:69], v12 offset:0
ds_read_b64_tr_b16 v[70:71], v12 offset:1024
s_waitcnt lgkmcnt(6)
v_mfma_f32_32x32x16_bf16 v[72:87], v[56:59], a[196:199], v[72:87]
ds_read_b64_tr_b16 v[48:49], v11 offset:2048
ds_read_b64_tr_b16 v[50:51], v11 offset:3072
buffer_load_dwordx4 v6, s[36:39], s68 offen offset:3072 lds
s_waitcnt lgkmcnt(6)
v_mfma_f32_32x32x16_bf16 v[88:103], v[60:63], a[196:199], v[88:103]
ds_read_b64_tr_b16 v[52:53], v12 offset:2048
ds_read_b64_tr_b16 v[54:55], v12 offset:3072
s_waitcnt lgkmcnt(6)
v_mfma_f32_32x32x16_bf16 v[72:87], v[64:67], a[200:203], v[72:87]
ds_read_b64_tr_b16 v[56:57], v11 offset:4096
ds_read_b64_tr_b16 v[58:59], v11 offset:5120
s_add_u32 s68, s44, 65536
s_add_u32 m0, s52, 81920
s_nop 0
buffer_load_dwordx4 v3, s[36:39], s68 offen offset:0 lds
s_waitcnt lgkmcnt(6)
v_mfma_f32_32x32x16_bf16 v[88:103], v[68:71], a[200:203], v[88:103]
ds_read_b64_tr_b16 v[60:61], v12 offset:4096
ds_read_b64_tr_b16 v[62:63], v12 offset:5120
s_waitcnt lgkmcnt(6)
v_mfma_f32_32x32x16_bf16 v[72:87], v[48:51], a[204:207], v[72:87]
ds_read_b64_tr_b16 v[64:65], v11 offset:6144
ds_read_b64_tr_b16 v[66:67], v11 offset:7168
buffer_load_dwordx4 v4, s[36:39], s68 offen offset:1024 lds
s_waitcnt lgkmcnt(6)
v_mfma_f32_32x32x16_bf16 v[88:103], v[52:55], a[204:207], v[88:103]
ds_read_b64_tr_b16 v[68:69], v12 offset:6144
ds_read_b64_tr_b16 v[70:71], v12 offset:7168
s_waitcnt lgkmcnt(6)
v_mfma_f32_32x32x16_bf16 v[72:87], v[56:59], a[208:211], v[72:87]
s_waitcnt vmcnt(40)
s_waitcnt vmcnt(33)
s_barrier
ds_read_b64_tr_b16 v[48:49], v11 offset:16384
ds_read_b64_tr_b16 v[50:51], v11 offset:17408
buffer_load_dwordx4 v5, s[36:39], s68 offen offset:2048 lds
s_waitcnt lgkmcnt(6)
v_mfma_f32_32x32x16_bf16 v[88:103], v[60:63], a[208:211], v[88:103]
ds_read_b64_tr_b16 v[52:53], v12 offset:16384
ds_read_b64_tr_b16 v[54:55], v12 offset:17408
s_waitcnt lgkmcnt(6)
v_mfma_f32_32x32x16_bf16 v[72:87], v[64:67], a[212:215], v[72:87]
ds_read_b64_tr_b16 v[56:57], v11 offset:18432
ds_read_b64_tr_b16 v[58:59], v11 offset:19456
buffer_load_dwordx4 v6, s[36:39], s68 offen offset:3072 lds
s_waitcnt lgkmcnt(6)
v_mfma_f32_32x32x16_bf16 v[88:103], v[68:71], a[212:215], v[88:103]
ds_read_b64_tr_b16 v[60:61], v12 offset:18432
ds_read_b64_tr_b16 v[62:63], v12 offset:19456
s_waitcnt lgkmcnt(6)
v_mfma_f32_32x32x16_bf16 v[72:87], v[48:51], a[216:219], v[72:87]
ds_read_b64_tr_b16 v[64:65], v11 offset:20480
ds_read_b64_tr_b16 v[66:67], v11 offset:21504
s_add_u32 s68, s44, 131072
s_add_u32 m0, s52, 98304
s_nop 0
buffer_load_dwordx4 v3, s[36:39], s68 offen offset:0 lds
s_waitcnt lgkmcnt(6)
v_mfma_f32_32x32x16_bf16 v[88:103], v[52:55], a[216:219], v[88:103]
ds_read_b64_tr_b16 v[68:69], v12 offset:20480
ds_read_b64_tr_b16 v[70:71], v12 offset:21504
s_waitcnt lgkmcnt(6)
v_mfma_f32_32x32x16_bf16 v[72:87], v[56:59], a[220:223], v[72:87]
ds_read_b64_tr_b16 v[48:49], v11 offset:22528
ds_read_b64_tr_b16 v[50:51], v11 offset:23552
buffer_load_dwordx4 v4, s[36:39], s68 offen offset:1024 lds
s_waitcnt lgkmcnt(6)
v_mfma_f32_32x32x16_bf16 v[88:103], v[60:63], a[220:223], v[88:103]
ds_read_b64_tr_b16 v[52:53], v12 offset:22528
ds_read_b64_tr_b16 v[54:55], v12 offset:23552
s_waitcnt lgkmcnt(6)
v_mfma_f32_32x32x16_bf16 v[72:87], v[64:67], a[224:227], v[72:87]
ds_read_b64_tr_b16 v[56:57], v7 offset:0
ds_read_b64_tr_b16 v[58:59], v7 offset:1024
buffer_load_dwordx4 v5, s[36:39], s68 offen offset:2048 lds
s_waitcnt lgkmcnt(6)
v_mfma_f32_32x32x16_bf16 v[88:103], v[68:71], a[224:227], v[88:103]
ds_read_b64_tr_b16 v[60:61], v8 offset:0
ds_read_b64_tr_b16 v[62:63], v8 offset:1024
s_waitcnt lgkmcnt(6)
v_mfma_f32_32x32x16_bf16 v[72:87], v[48:51], a[228:231], v[72:87]
ds_read_b64_tr_b16 v[64:65], v7 offset:2048
ds_read_b64_tr_b16 v[66:67], v7 offset:3072
buffer_load_dwordx4 v6, s[36:39], s68 offen offset:3072 lds
s_waitcnt lgkmcnt(6)
v_mfma_f32_32x32x16_bf16 v[88:103], v[52:55], a[228:231], v[88:103]
ds_read_b64_tr_b16 v[68:69], v8 offset:2048
ds_read_b64_tr_b16 v[70:71], v8 offset:3072
s_waitcnt lgkmcnt(6)
v_mfma_f32_32x32x16_bf16 v[72:87], v[56:59], a[232:235], v[72:87]
ds_read_b64_tr_b16 v[48:49], v7 offset:4096
ds_read_b64_tr_b16 v[50:51], v7 offset:5120
s_add_u32 s68, s44, 196608
s_add_u32 m0, s52, 114688
s_nop 0
buffer_load_dwordx4 v3, s[36:39], s68 offen offset:0 lds
s_waitcnt lgkmcnt(6)
v_mfma_f32_32x32x16_bf16 v[88:103], v[60:63], a[232:235], v[88:103]
ds_read_b64_tr_b16 v[52:53], v8 offset:4096
ds_read_b64_tr_b16 v[54:55], v8 offset:5120
s_waitcnt lgkmcnt(6)
v_mfma_f32_32x32x16_bf16 v[72:87], v[64:67], a[236:239], v[72:87]
ds_read_b64_tr_b16 v[56:57], v7 offset:6144
ds_read_b64_tr_b16 v[58:59], v7 offset:7168
buffer_load_dwordx4 v4, s[36:39], s68 offen offset:1024 lds
s_waitcnt lgkmcnt(6)
v_mfma_f32_32x32x16_bf16 v[88:103], v[68:71], a[236:239], v[88:103]
ds_read_b64_tr_b16 v[60:61], v8 offset:6144
ds_read_b64_tr_b16 v[62:63], v8 offset:7168
s_waitcnt lgkmcnt(6)
s_waitcnt vmcnt(40)
v_mfma_f32_32x32x16_bf16 v[72:87], v[48:51], a[240:243], v[72:87]
s_waitcnt vmcnt(33)
s_waitcnt vmcnt(25)
s_barrier
ds_read_b64_tr_b16 v[64:65], v7 offset:16384
ds_read_b64_tr_b16 v[66:67], v7 offset:17408
buffer_load_dwordx4 v5, s[36:39], s68 offen offset:2048 lds
s_waitcnt lgkmcnt(6)
v_mfma_f32_32x32x16_bf16 v[88:103], v[52:55], a[240:243], v[88:103]
ds_read_b64_tr_b16 v[68:69], v8 offset:16384
ds_read_b64_tr_b16 v[70:71], v8 offset:17408
s_waitcnt lgkmcnt(6)
v_mfma_f32_32x32x16_bf16 v[72:87], v[56:59], a[244:247], v[72:87]
ds_read_b64_tr_b16 v[48:49], v7 offset:18432
ds_read_b64_tr_b16 v[50:51], v7 offset:19456
buffer_load_dwordx4 v6, s[36:39], s68 offen offset:3072 lds
s_waitcnt lgkmcnt(6)
v_mfma_f32_32x32x16_bf16 v[88:103], v[60:63], a[244:247], v[88:103]
ds_read_b64_tr_b16 v[52:53], v8 offset:18432
ds_read_b64_tr_b16 v[54:55], v8 offset:19456
s_waitcnt lgkmcnt(6)
v_mfma_f32_32x32x16_bf16 v[72:87], v[64:67], a[248:251], v[72:87]
ds_read_b64_tr_b16 v[56:57], v7 offset:20480
ds_read_b64_tr_b16 v[58:59], v7 offset:21504
s_waitcnt lgkmcnt(6)
v_mfma_f32_32x32x16_bf16 v[88:103], v[68:71], a[248:251], v[88:103]
ds_read_b64_tr_b16 v[60:61], v8 offset:20480
ds_read_b64_tr_b16 v[62:63], v8 offset:21504
s_waitcnt vmcnt(21)
s_mov_b32 s21, 20000
fl_28:
v_cmp_ne_u32 vcc, s17, v13
s_cbranch_vccz fok_27
s_sub_u32 s21, s21, 1
s_cmp_eq_u32 s21, 0
s_cbranch_scc1 fok_27
buffer_load_dword v13, v14, s[4:7], s31 offen sc1
s_waitcnt vmcnt(0)
s_branch fl_28
fok_27:
s_add_u32 s69, s60, 0
buffer_load_dwordx4 a[104:107], v2, s[4:7], s69 offen offset:0 sc1
s_waitcnt lgkmcnt(6)
v_mfma_f32_32x32x16_bf16 v[72:87], v[48:51], a[252:255], v[72:87]
ds_read_b64_tr_b16 v[64:65], v7 offset:22528
ds_read_b64_tr_b16 v[66:67], v7 offset:23552
s_waitcnt lgkmcnt(6)
v_mfma_f32_32x32x16_bf16 v[88:103], v[52:55], a[252:255], v[88:103]
ds_read_b64_tr_b16 v[68:69], v8 offset:22528
ds_read_b64_tr_b16 v[70:71], v8 offset:23552
buffer_load_dwordx4 a[108:111], v2, s[4:7], s69 offen offset:1024 sc1
s_waitcnt lgkmcnt(6)
v_mfma_f32_32x32x16_bf16 v[72:87], v[56:59], a[64:67], v[72:87]
ds_read_b64_tr_b16 v[48:49], v7 offset:32768
ds_read_b64_tr_b16 v[50:51], v7 offset:33792
s_waitcnt lgkmcnt(6)
v_mfma_f32_32x32x16_bf16 v[88:103], v[60:63], a[64:67], v[88:103]
ds_read_b64_tr_b16 v[52:53], v8 offset:32768
ds_read_b64_tr_b16 v[54:55], v8 offset:33792
buffer_load_dwordx4 a[112:115], v2, s[4:7], s69 offen offset:2048 sc1
s_waitcnt lgkmcnt(6)
v_mfma_f32_32x32x16_bf16 v[72:87], v[64:67], a[68:71], v[72:87]
ds_read_b64_tr_b16 v[56:57], v7 offset:34816
ds_read_b64_tr_b16 v[58:59], v7 offset:35840
s_waitcnt lgkmcnt(6)
v_mfma_f32_32x32x16_bf16 v[88:103], v[68:71], a[68:71], v[88:103]
ds_read_b64_tr_b16 v[60:61], v8 offset:34816
ds_read_b64_tr_b16 v[62:63], v8 offset:35840
buffer_load_dwordx4 a[116:119], v2, s[4:7], s69 offen offset:3072 sc1
s_waitcnt lgkmcnt(6)
v_mfma_f32_32x32x16_bf16 v[72:87], v[48:51], a[72:75], v[72:87]
ds_read_b64_tr_b16 v[64:65], v7 offset:36864
ds_read_b64_tr_b16 v[66:67], v7 offset:37888
s_waitcnt lgkmcnt(6)
v_mfma_f32_32x32x16_bf16 v[88:103], v[52:55], a[72:75], v[88:103]
ds_read_b64_tr_b16 v[68:69], v8 offset:36864
ds_read_b64_tr_b16 v[70:71], v8 offset:37888
s_add_u32 s69, s60, 4096
buffer_load_dwordx4 a[120:123], v2, s[4:7], s69 offen offset:0 sc1
s_waitcnt lgkmcnt(6)
v_mfma_f32_32x32x16_bf16 v[72:87], v[56:59], a[76:79], v[72:87]
ds_read_b64_tr_b16 v[48:49], v7 offset:38912
ds_read_b64_tr_b16 v[50:51], v7 offset:39936
s_waitcnt lgkmcnt(6)
v_mfma_f32_32x32x16_bf16 v[88:103], v[60:63], a[76:79], v[88:103]
ds_read_b64_tr_b16 v[52:53], v8 offset:38912
ds_read_b64_tr_b16 v[54:55], v8 offset:39936
buffer_load_dwordx4 a[124:127], v2, s[4:7], s69 offen offset:1024 sc1
s_waitcnt lgkmcnt(6)
v_mfma_f32_32x32x16_bf16 v[72:87], v[64:67], a[80:83], v[72:87]
s_waitcnt vmcnt(24)
s_waitcnt vmcnt(18)
s_barrier
ds_read_b64_tr_b16 v[56:57], v7 offset:49152
ds_read_b64_tr_b16 v[58:59], v7 offset:50176
s_waitcnt lgkmcnt(6)
v_mfma_f32_32x32x16_bf16 v[88:103], v[68:71], a[80:83], v[88:103]
ds_read_b64_tr_b16 v[60:61], v8 offset:49152
ds_read_b64_tr_b16 v[62:63], v8 offset:50176
buffer_load_dwordx4 a[136:139], v2, s[4:7], s69 offen offset:2048 sc1
s_waitcnt lgkmcnt(6)
v_mfma_f32_32x32x16_bf16 v[72:87], v[48:51], a[84:87], v[72:87]
ds_read_b64_tr_b16 v[64:65], v7 offset:51200
ds_read_b64_tr_b16 v[66:67], v7 offset:52224
s_waitcnt lgkmcnt(6)
v_mfma_f32_32x32x16_bf16 v[88:103], v[52:55], a[84:87], v[88:103]
ds_read_b64_tr_b16 v[68:69], v8 offset:51200
ds_read_b64_tr_b16 v[70:71], v8 offset:52224
buffer_load_dwordx4 a[140:143], v2, s[4:7], s69 offen offset:3072 sc1
s_waitcnt lgkmcnt(6)
v_mfma_f32_32x32x16_bf16 v[72:87], v[56:59], a[88:91], v[72:87]
ds_read_b64_tr_b16 v[48:49], v7 offset:53248
ds_read_b64_tr_b16 v[50:51], v7 offset:54272
s_waitcnt lgkmcnt(6)
v_mfma_f32_32x32x16_bf16 v[88:103], v[60:63], a[88:91], v[88:103]
ds_read_b64_tr_b16 v[52:53], v8 offset:53248
ds_read_b64_tr_b16 v[54:55], v8 offset:54272
s_add_u32 s69, s60, 8192
buffer_load_dwordx4 a[144:147], v2, s[4:7], s69 offen offset:0 sc1
s_waitcnt lgkmcnt(6)
v_mfma_f32_32x32x16_bf16 v[72:87], v[64:67], a[92:95], v[72:87]
ds_read_b64_tr_b16 v[56:57], v7 offset:55296
ds_read_b64_tr_b16 v[58:59], v7 offset:56320
s_waitcnt lgkmcnt(6)
v_mfma_f32_32x32x16_bf16 v[88:103], v[68:71], a[92:95], v[88:103]
ds_read_b64_tr_b16 v[60:61], v8 offset:55296
ds_read_b64_tr_b16 v[62:63], v8 offset:56320
buffer_load_dwordx4 a[148:151], v2, s[4:7], s69 offen offset:1024 sc1
s_waitcnt lgkmcnt(6)
v_mfma_f32_32x32x16_bf16 v[72:87], v[48:51], a[96:99], v[72:87]
ds_read_b64_tr_b16 v[64:65], v9 offset:0
ds_read_b64_tr_b16 v[66:67], v9 offset:1024
s_waitcnt lgkmcnt(6)
v_mfma_f32_32x32x16_bf16 v[88:103], v[52:55], a[96:99], v[88:103]
ds_read_b64_tr_b16 v[68:69], v10 offset:0
ds_read_b64_tr_b16 v[70:71], v10 offset:1024
buffer_load_dwordx4 a[152:155], v2, s[4:7], s69 offen offset:2048 sc1
s_waitcnt lgkmcnt(6)
v_mfma_f32_32x32x16_bf16 v[72:87], v[56:59], a[100:103], v[72:87]
ds_read_b64_tr_b16 v[48:49], v9 offset:2048
ds_read_b64_tr_b16 v[50:51], v9 offset:3072
s_waitcnt lgkmcnt(6)
v_mfma_f32_32x32x16_bf16 v[88:103], v[60:63], a[100:103], v[88:103]
ds_read_b64_tr_b16 v[52:53], v10 offset:2048
ds_read_b64_tr_b16 v[54:55], v10 offset:3072
buffer_load_dwordx4 a[156:159], v2, s[4:7], s69 offen offset:3072 sc1
s_waitcnt lgkmcnt(6)
s_waitcnt vmcnt(11)
v_mfma_f32_32x32x16_bf16 v[104:119], v[64:67], a[104:107], 0
ds_read_b64_tr_b16 v[56:57], v9 offset:4096
ds_read_b64_tr_b16 v[58:59], v9 offset:5120
s_waitcnt lgkmcnt(6)
v_mfma_f32_32x32x16_bf16 v[120:135], v[68:71], a[104:107], 0
ds_read_b64_tr_b16 v[60:61], v10 offset:4096
ds_read_b64_tr_b16 v[62:63], v10 offset:5120
s_add_u32 s69, s60, 12288
buffer_load_dwordx4 a[160:163], v2, s[4:7], s69 offen offset:0 sc1
s_waitcnt lgkmcnt(6)
s_waitcnt vmcnt(11)
v_mfma_f32_32x32x16_bf16 v[104:119], v[48:51], a[108:111], v[104:119]
ds_write_b128 v141, v[88:91] offset:0
ds_write_b128 v141, v[92:95] offset:1024
ds_write_b128 v141, v[96:99] offset:2048
ds_write_b128 v141, v[100:103] offset:3072
ds_read_b64_tr_b16 v[64:65], v9 offset:6144
ds_read_b64_tr_b16 v[66:67], v9 offset:7168
s_waitcnt lgkmcnt(10)
v_mfma_f32_32x32x16_bf16 v[120:135], v[52:55], a[108:111], v[120:135]
ds_read_b64_tr_b16 v[68:69], v10 offset:6144
ds_read_b64_tr_b16 v[70:71], v10 offset:7168
buffer_load_dwordx4 a[164:167], v2, s[4:7], s69 offen offset:1024 sc1
s_waitcnt lgkmcnt(10)
s_waitcnt vmcnt(11)
v_mfma_f32_32x32x16_bf16 v[104:119], v[56:59], a[112:115], v[104:119]
s_waitcnt lgkmcnt(4)
s_barrier
ds_read_b64_tr_b16 v[48:49], v9 offset:16384
ds_read_b64_tr_b16 v[50:51], v9 offset:17408
ds_read_b128 v[88:91], v142 offset:0
v_mfma_f32_32x32x16_bf16 v[120:135], v[60:63], a[112:115], v[120:135]
ds_read_b64_tr_b16 v[52:53], v10 offset:16384
ds_read_b64_tr_b16 v[54:55], v10 offset:17408
buffer_load_dwordx4 a[168:171], v2, s[4:7], s69 offen offset:2048 sc1
ds_read_b128 v[92:95], v142 offset:1024
s_waitcnt lgkmcnt(8)
s_waitcnt vmcnt(11)
v_mfma_f32_32x32x16_bf16 v[104:119], v[64:67], a[116:119], v[104:119]
ds_read_b64_tr_b16 v[56:57], v9 offset:18432
ds_read_b64_tr_b16 v[58:59], v9 offset:19456
ds_read_b128 v[96:99], v142 offset:2048
ds_read_b128 v[100:103], v142 offset:3072
s_waitcnt lgkmcnt(10)
v_mfma_f32_32x32x16_bf16 v[120:135], v[68:71], a[116:119], v[120:135]
ds_read_b64_tr_b16 v[60:61], v10 offset:18432
ds_read_b64_tr_b16 v[62:63], v10 offset:19456
buffer_load_dwordx4 a[172:175], v2, s[4:7], s69 offen offset:3072 sc1
s_waitcnt lgkmcnt(10)
s_waitcnt vmcnt(11)
v_mfma_f32_32x32x16_bf16 v[104:119], v[48:51], a[120:123], v[104:119]
ds_read_b64_tr_b16 v[64:65], v9 offset:20480
ds_read_b64_tr_b16 v[66:67], v9 offset:21504
v_mul_f32 v146, 0xbfb8aa3b, v24
v_mov_b32 v144, v24
s_waitcnt lgkmcnt(9)
v_mfma_f32_32x32x16_bf16 v[120:135], v[52:55], a[120:123], v[120:135]
ds_read_b64_tr_b16 v[68:69], v10 offset:20480
ds_read_b64_tr_b16 v[70:71], v10 offset:21504
v_mov_b32 v145, v24
s_waitcnt lgkmcnt(8)
s_waitcnt vmcnt(10)
v_mfma_f32_32x32x16_bf16 v[104:119], v[56:59], a[124:127], v[104:119]
ds_read_b64_tr_b16 v[48:49], v9 offset:22528
ds_read_b64_tr_b16 v[50:51], v9 offset:23552
s_waitcnt lgkmcnt(8)
v_add_f32 v72, v72, v88
v_add_f32 v73, v73, v89
s_waitcnt lgkmcnt(6)
v_mfma_f32_32x32x16_bf16 v[120:135], v[60:63], a[124:127], v[120:135]
ds_read_b64_tr_b16 v[52:53], v10 offset:22528
ds_read_b64_tr_b16 v[54:55], v10 offset:23552
v_add_f32 v74, v74, v90
v_add_f32 v75, v75, v91
s_waitcnt lgkmcnt(6)
s_waitcnt vmcnt(9)
v_mfma_f32_32x32x16_bf16 v[104:119], v[64:67], a[136:139], v[104:119]
ds_read_b64_tr_b16 v[56:57], v9 offset:32768
ds_read_b64_tr_b16 v[58:59], v9 offset:33792
v_add_f32 v76, v76, v92
v_add_f32 v77, v77, v93
v_add_f32 v78, v78, v94
s_waitcnt lgkmcnt(6)
v_mfma_f32_32x32x16_bf16 v[120:135], v[68:71], a[136:139], v[120:135]
ds_read_b64_tr_b16 v[60:61], v10 offset:32768
ds_read_b64_tr_b16 v[62:63], v10 offset:33792
v_add_f32 v79, v79, v95
v_add_f32 v80, v80, v96
s_waitcnt lgkmcnt(6)
s_waitcnt vmcnt(8)
v_mfma_f32_32x32x16_bf16 v[104:119], v[48:51], a[140:143], v[104:119]
ds_read_b64_tr_b16 v[64:65], v9 offset:34816
ds_read_b64_tr_b16 v[66:67], v9 offset:35840
v_add_f32 v81, v81, v97
v_add_f32 v82, v82, v98
v_add_f32 v83, v83, v99
s_waitcnt lgkmcnt(6)
v_mfma_f32_32x32x16_bf16 v[120:135], v[52:55], a[140:143], v[120:135]
ds_read_b64_tr_b16 v[68:69], v10 offset:34816
ds_read_b64_tr_b16 v[70:71], v10 offset:35840
v_add_f32 v84, v84, v100
v_add_f32 v85, v85, v101
s_waitcnt lgkmcnt(6)
s_waitcnt vmcnt(7)
v_mfma_f32_32x32x16_bf16 v[104:119], v[56:59], a[144:147], v[104:119]
ds_read_b64_tr_b16 v[48:49], v9 offset:36864
ds_read_b64_tr_b16 v[50:51], v9 offset:37888
v_add_f32 v86, v86, v102
v_add_f32 v87, v87, v103
v_mul_f32 v88, v146, v72
s_waitcnt lgkmcnt(6)
v_mfma_f32_32x32x16_bf16 v[120:135], v[60:63], a[144:147], v[120:135]
ds_read_b64_tr_b16 v[52:53], v10 offset:36864
ds_read_b64_tr_b16 v[54:55], v10 offset:37888
v_mul_f32 v89, v146, v73
v_mul_f32 v90, v146, v74
s_waitcnt lgkmcnt(6)
s_waitcnt vmcnt(6)
v_mfma_f32_32x32x16_bf16 v[104:119], v[64:67], a[148:151], v[104:119]
ds_read_b64_tr_b16 v[56:57], v9 offset:38912
ds_read_b64_tr_b16 v[58:59], v9 offset:39936
v_mul_f32 v91, v146, v75
v_exp_f32 v88, v88
v_exp_f32 v89, v89
s_waitcnt lgkmcnt(6)
v_mfma_f32_32x32x16_bf16 v[120:135], v[68:71], a[148:151], v[120:135]
ds_read_b64_tr_b16 v[60:61], v10 offset:38912
ds_read_b64_tr_b16 v[62:63], v10 offset:39936
v_exp_f32 v90, v90
v_exp_f32 v91, v91
s_waitcnt lgkmcnt(6)
s_waitcnt vmcnt(5)
v_mfma_f32_32x32x16_bf16 v[104:119], v[48:51], a[152:155], v[104:119]
s_barrier
ds_read_b64_tr_b16 v[64:65], v9 offset:49152
ds_read_b64_tr_b16 v[66:67], v9 offset:50176
v_add_f32 v88, 1.0, v88
v_add_f32 v89, 1.0, v89
s_waitcnt lgkmcnt(6)
v_mfma_f32_32x32x16_bf16 v[120:135], v[52:55], a[152:155], v[120:135]
ds_read_b64_tr_b16 v[68:69], v10 offset:49152
ds_read_b64_tr_b16 v[70:71], v10 offset:50176
v_add_f32 v90, 1.0, v90
v_add_f32 v91, 1.0, v91
s_waitcnt lgkmcnt(6)
s_waitcnt vmcnt(4)
v_mfma_f32_32x32x16_bf16 v[104:119], v[56:59], a[156:159], v[104:119]
ds_read_b64_tr_b16 v[48:49], v9 offset:51200
ds_read_b64_tr_b16 v[50:51], v9 offset:52224
v_rcp_f32 v88, v88
v_rcp_f32 v89, v89
v_rcp_f32 v90, v90
s_waitcnt lgkmcnt(6)
v_mfma_f32_32x32x16_bf16 v[120:135], v[60:63], a[156:159], v[120:135]
ds_read_b64_tr_b16 v[52:53], v10 offset:51200
ds_read_b64_tr_b16 v[54:55], v10 offset:52224
v_rcp_f32 v91, v91
v_mul_f32 v72, v72, v88
s_waitcnt lgkmcnt(6)
s_waitcnt vmcnt(3)
v_mfma_f32_32x32x16_bf16 v[104:119], v[64:67], a[160:163], v[104:119]
ds_read_b64_tr_b16 v[56:57], v9 offset:53248
ds_read_b64_tr_b16 v[58:59], v9 offset:54272
v_mul_f32 v73, v73, v89
v_mul_f32 v74, v74, v90
v_mul_f32 v75, v75, v91
s_waitcnt lgkmcnt(6)
v_mfma_f32_32x32x16_bf16 v[120:135], v[68:71], a[160:163], v[120:135]
ds_read_b64_tr_b16 v[60:61], v10 offset:53248
ds_read_b64_tr_b16 v[62:63], v10 offset:54272
v_mul_f32 v92, v146, v76
v_mul_f32 v93, v146, v77
s_waitcnt lgkmcnt(6)
s_waitcnt vmcnt(2)
v_mfma_f32_32x32x16_bf16 v[104:119], v[48:51], a[164:167], v[104:119]
ds_read_b64_tr_b16 v[64:65], v9 offset:55296
ds_read_b64_tr_b16 v[66:67], v9 offset:56320
v_mul_f32 v94, v146, v78
v_mul_f32 v95, v146, v79
v_exp_f32 v92, v92
s_waitcnt lgkmcnt(6)
v_mfma_f32_32x32x16_bf16 v[120:135], v[52:55], a[164:167], v[120:135]
ds_read_b64_tr_b16 v[68:69], v10 offset:55296
ds_read_b64_tr_b16 v[70:71], v10 offset:56320
v_exp_f32 v93, v93
v_exp_f32 v94, v94
s_waitcnt lgkmcnt(6)
s_waitcnt vmcnt(1)
v_mfma_f32_32x32x16_bf16 v[104:119], v[56:59], a[168:171], v[104:119]
v_exp_f32 v95, v95
v_add_f32 v92, 1.0, v92
v_add_f32 v93, 1.0, v93
v_add_f32 v94, 1.0, v94
v_add_f32 v95, 1.0, v95
s_waitcnt lgkmcnt(4)
v_mfma_f32_32x32x16_bf16 v[120:135], v[60:63], a[168:171], v[120:135]
v_rcp_f32 v92, v92
v_rcp_f32 v93, v93
v_rcp_f32 v94, v94
v_rcp_f32 v95, v95
s_waitcnt lgkmcnt(2)
s_waitcnt vmcnt(0)
v_mfma_f32_32x32x16_bf16 v[104:119], v[64:67], a[172:175], v[104:119]
v_mul_f32 v76, v76, v92
v_mul_f32 v77, v77, v93
v_mul_f32 v78, v78, v94
v_mul_f32 v79, v79, v95
v_mul_f32 v96, v146, v80
s_waitcnt lgkmcnt(0)
v_mfma_f32_32x32x16_bf16 v[120:135], v[68:71], a[172:175], v[120:135]
v_mul_f32 v97, v146, v81
v_mul_f32 v98, v146, v82
v_mul_f32 v99, v146, v83
v_exp_f32 v96, v96
s_nop 7
ds_write_b128 v141, v[120:123] offset:16384
ds_write_b128 v141, v[124:127] offset:17408
ds_write_b128 v141, v[128:131] offset:18432
ds_write_b128 v141, v[132:135] offset:19456
s_waitcnt lgkmcnt(0)
s_barrier
ds_read_b128 v[120:123], v142 offset:16384
ds_read_b128 v[124:127], v142 offset:17408
ds_read_b128 v[128:131], v142 offset:18432
ds_read_b128 v[132:135], v142 offset:19456
v_exp_f32 v97, v97
v_exp_f32 v98, v98
v_exp_f32 v99, v99
v_add_f32 v96, 1.0, v96
v_add_f32 v97, 1.0, v97
v_add_f32 v98, 1.0, v98
v_add_f32 v99, 1.0, v99
v_rcp_f32 v96, v96
v_rcp_f32 v97, v97
v_rcp_f32 v98, v98
v_rcp_f32 v99, v99
v_mul_f32 v80, v80, v96
v_mul_f32 v81, v81, v97
v_mul_f32 v82, v82, v98
v_mul_f32 v83, v83, v99
v_mul_f32 v100, v146, v84
v_mul_f32 v101, v146, v85
v_mul_f32 v102, v146, v86
v_mul_f32 v103, v146, v87
v_exp_f32 v100, v100
v_exp_f32 v101, v101
v_exp_f32 v102, v102
v_exp_f32 v103, v103
v_add_f32 v100, 1.0, v100
v_add_f32 v101, 1.0, v101
v_add_f32 v102, 1.0, v102
v_add_f32 v103, 1.0, v103
v_rcp_f32 v100, v100
v_rcp_f32 v101, v101
v_rcp_f32 v102, v102
v_rcp_f32 v103, v103
v_mul_f32 v84, v84, v100
v_mul_f32 v85, v85, v101
v_mul_f32 v86, v86, v102
v_mul_f32 v87, v87, v103
s_waitcnt vmcnt(0)
s_waitcnt lgkmcnt(0)
v_pk_add_f32 v[104:105], v[104:105], v[120:121]
v_pk_add_f32 v[106:107], v[106:107], v[122:123]
v_pk_add_f32 v[108:109], v[108:109], v[124:125]
v_pk_add_f32 v[110:111], v[110:111], v[126:127]
v_pk_add_f32 v[112:113], v[112:113], v[128:129]
v_pk_add_f32 v[114:115], v[114:115], v[130:131]
v_pk_add_f32 v[116:117], v[116:117], v[132:133]
v_pk_add_f32 v[118:119], v[118:119], v[134:135]
v_pk_mul_f32 v[72:73], v[72:73], v[144:145]
v_pk_mul_f32 v[74:75], v[74:75], v[144:145]
v_pk_mul_f32 v[76:77], v[76:77], v[144:145]
v_pk_mul_f32 v[78:79], v[78:79], v[144:145]
v_pk_mul_f32 v[80:81], v[80:81], v[144:145]
v_pk_mul_f32 v[82:83], v[82:83], v[144:145]
v_pk_mul_f32 v[84:85], v[84:85], v[144:145]
v_pk_mul_f32 v[86:87], v[86:87], v[144:145]
v_pk_mul_f32 v[104:105], v[104:105], v[72:73]
v_pk_mul_f32 v[106:107], v[106:107], v[74:75]
v_pk_mul_f32 v[108:109], v[108:109], v[76:77]
v_pk_mul_f32 v[110:111], v[110:111], v[78:79]
v_pk_mul_f32 v[112:113], v[112:113], v[80:81]
v_pk_mul_f32 v[114:115], v[114:115], v[82:83]
v_pk_mul_f32 v[116:117], v[116:117], v[84:85]
v_pk_mul_f32 v[118:119], v[118:119], v[86:87]
v_permlane32_swap_b32 v104, v108
v_permlane32_swap_b32 v105, v109
v_permlane32_swap_b32 v106, v110
v_permlane32_swap_b32 v107, v111
v_permlane32_swap_b32 v112, v116
v_permlane32_swap_b32 v113, v117
v_permlane32_swap_b32 v114, v118
v_permlane32_swap_b32 v115, v119
v_lshlrev_b32 v28, 16, v16
v_and_b32 v29, 0xffff0000, v16
v_pk_add_f32 v[28:29], v[28:29], v[104:105]
v_cvt_pk_bf16_f32 v16, v28, v29
v_lshlrev_b32 v30, 16, v17
v_and_b32 v31, 0xffff0000, v17
v_pk_add_f32 v[30:31], v[30:31], v[106:107]
v_cvt_pk_bf16_f32 v17, v30, v31
v_lshlrev_b32 v28, 16, v18
v_and_b32 v29, 0xffff0000, v18
v_pk_add_f32 v[28:29], v[28:29], v[108:109]
v_cvt_pk_bf16_f32 v18, v28, v29
v_lshlrev_b32 v30, 16, v19
v_and_b32 v31, 0xffff0000, v19
v_pk_add_f32 v[30:31], v[30:31], v[110:111]
v_cvt_pk_bf16_f32 v19, v30, v31
v_lshlrev_b32 v28, 16, v20
v_and_b32 v29, 0xffff0000, v20
v_pk_add_f32 v[28:29], v[28:29], v[112:113]
v_cvt_pk_bf16_f32 v20, v28, v29
v_lshlrev_b32 v30, 16, v21
v_and_b32 v31, 0xffff0000, v21
v_pk_add_f32 v[30:31], v[30:31], v[114:115]
v_cvt_pk_bf16_f32 v21, v30, v31
v_lshlrev_b32 v28, 16, v22
v_and_b32 v29, 0xffff0000, v22
v_pk_add_f32 v[28:29], v[28:29], v[116:117]
v_cvt_pk_bf16_f32 v22, v28, v29
v_lshlrev_b32 v30, 16, v23
v_and_b32 v31, 0xffff0000, v23
v_pk_add_f32 v[30:31], v[30:31], v[118:119]
v_cvt_pk_bf16_f32 v23, v30, v31
v_and_b32 v32, 15, v1
v_lshlrev_b32 v32, 10, v32
v_bfe_u32 v33, v1, 4, 1
v_lshlrev_b32 v33, 5, v33
v_lshrrev_b32 v34, 5, v1
v_lshlrev_b32 v34, 4, v34
v_add3_u32 v32, v32, v33, v34
v_permlane16_swap_b32 v16, v20
v_permlane16_swap_b32 v17, v21
v_permlane16_swap_b32 v18, v22
v_permlane16_swap_b32 v19, v23
s_add_u32 s20, s61, 16384
buffer_store_dwordx4 v[16:19], v32, s[56:59], s61 offen
buffer_store_dwordx4 v[20:23], v32, s[56:59], s20 offen
recurrent_scan__sliding_block__dense_activation_relu__prompt_kernel_done:
s_endpgm
Lend:
fallback_20:
s_nop 7
s_nop 7
v_mov_b32 v28, v186
v_and_b32 v33, 31, v1
v_lshrrev_b32 v34, 5, v1
v_lshlrev_b32 v34, 2, v34
v_sub_u32 v33, v33, v34
v_mov_b32 v35, 0xf149f2ca
v_mov_b32 v36, 0
v_mov_b32 v37, 0xffff
v_mov_b32 v38, 0xffff0000
s_cmp_lg_u32 s46, 0
s_cselect_b64 s[24:25], -1, 0
v_cndmask_b32 v39, v36, v35, s[24:25]
v_cmp_ge_i32 s[20:21], v33, 0
v_mov_b32 v136, v39
s_nop 0
v_cndmask_b32 v72, v36, v37, s[20:21]
v_cmp_ge_i32 s[20:21], v33, 1
v_mov_b32 v137, v39
s_nop 0
v_cndmask_b32 v73, v36, v38, s[20:21]
v_or_b32 v160, v72, v73
v_not_b32 v152, v160
v_cmp_ge_i32 s[20:21], v33, 2
v_mov_b32 v138, v39
s_nop 0
v_cndmask_b32 v72, v36, v37, s[20:21]
v_cmp_ge_i32 s[20:21], v33, 3
v_mov_b32 v139, v39
s_nop 0
v_cndmask_b32 v73, v36, v38, s[20:21]
v_or_b32 v161, v72, v73
v_not_b32 v153, v161
v_cmp_ge_i32 s[20:21], v33, 8
v_mov_b32 v140, v39
s_nop 0
v_cndmask_b32 v72, v36, v37, s[20:21]
v_cmp_ge_i32 s[20:21], v33, 9
v_mov_b32 v141, v39
s_nop 0
v_cndmask_b32 v73, v36, v38, s[20:21]
v_or_b32 v162, v72, v73
v_not_b32 v154, v162
v_cmp_ge_i32 s[20:21], v33, 10
v_mov_b32 v142, v39
s_nop 0
v_cndmask_b32 v72, v36, v37, s[20:21]
v_cmp_ge_i32 s[20:21], v33, 11
v_mov_b32 v143, v39
s_nop 0
v_cndmask_b32 v73, v36, v38, s[20:21]
v_or_b32 v163, v72, v73
v_not_b32 v155, v163
v_cmp_ge_i32 s[20:21], v33, 16
v_mov_b32 v144, v39
s_nop 0
v_cndmask_b32 v72, v36, v37, s[20:21]
v_cmp_ge_i32 s[20:21], v33, 17
v_mov_b32 v145, v39
s_nop 0
v_cndmask_b32 v73, v36, v38, s[20:21]
v_or_b32 v164, v72, v73
v_not_b32 v156, v164
v_cmp_ge_i32 s[20:21], v33, 18
v_mov_b32 v146, v39
s_nop 0
v_cndmask_b32 v72, v36, v37, s[20:21]
v_cmp_ge_i32 s[20:21], v33, 19
v_mov_b32 v147, v39
s_nop 0
v_cndmask_b32 v73, v36, v38, s[20:21]
v_or_b32 v165, v72, v73
v_not_b32 v157, v165
v_cmp_ge_i32 s[20:21], v33, 24
v_mov_b32 v148, v39
s_nop 0
v_cndmask_b32 v72, v36, v37, s[20:21]
v_cmp_ge_i32 s[20:21], v33, 25
v_mov_b32 v149, v39
s_nop 0
v_cndmask_b32 v73, v36, v38, s[20:21]
v_or_b32 v166, v72, v73
v_not_b32 v158, v166
v_cmp_ge_i32 s[20:21], v33, 26
v_mov_b32 v150, v39
s_nop 0
v_cndmask_b32 v72, v36, v37, s[20:21]
v_cmp_ge_i32 s[20:21], v33, 27
v_mov_b32 v151, v39
s_nop 0
v_cndmask_b32 v73, v36, v38, s[20:21]
v_or_b32 v167, v72, v73
v_not_b32 v159, v167
v_mov_b32 v184, 0xf149f2ca
v_mov_b32 v185, 0xf149f2ca
ds_read_b128 a[0:3], v27 offset:0
s_waitcnt lgkmcnt(0)
v_mfma_f32_32x32x16_bf16 v[40:55], a[0:3], a[128:131], v[104:119]
ds_read_b128 a[4:7], v27 offset:1024
s_waitcnt lgkmcnt(0)
v_mfma_f32_32x32x16_bf16 v[56:71], a[4:7], a[128:131], v[136:151]
v_mfma_f32_32x32x16_bf16 v[88:103], a[4:7], a[132:135], v[104:119]
ds_read_b128 a[0:3], v27 offset:2048
s_nop 6
v_max3_f32 v184, v40, v41, v184
v_max3_f32 v184, v42, v43, v184
v_max3_f32 v184, v44, v45, v184
v_max3_f32 v184, v46, v47, v184
v_max3_f32 v184, v48, v49, v184
v_max3_f32 v184, v50, v51, v184
v_max3_f32 v184, v52, v53, v184
v_max3_f32 v184, v54, v55, v184
s_cmp_lg_u32 s46, 2
s_cbranch_scc1 tv_29
v_mov_b32 v136, 0
v_mov_b32 v137, 0
v_mov_b32 v138, 0
v_mov_b32 v139, 0
v_mov_b32 v140, 0
v_mov_b32 v141, 0
v_mov_b32 v142, 0
v_mov_b32 v143, 0
v_mov_b32 v144, 0
v_mov_b32 v145, 0
v_mov_b32 v146, 0
v_mov_b32 v147, 0
v_mov_b32 v148, 0
v_mov_b32 v149, 0
v_mov_b32 v150, 0
v_mov_b32 v151, 0
tv_29:
s_waitcnt lgkmcnt(0)
s_nop 0
v_mfma_f32_32x32x16_bf16 v[40:55], a[0:3], a[128:131], v[136:151]
v_mfma_f32_32x32x16_bf16 v[72:87], a[0:3], a[132:135], v[136:151]
ds_read_b128 a[4:7], v27 offset:3072
v_max3_f32 v184, v56, v57, v184
v_max3_f32 v184, v58, v59, v184
v_max3_f32 v184, v60, v61, v184
v_max3_f32 v184, v62, v63, v184
v_max3_f32 v184, v64, v65, v184
v_max3_f32 v184, v66, v67, v184
v_max3_f32 v184, v68, v69, v184
v_max3_f32 v184, v70, v71, v184
v_max3_f32 v185, v88, v89, v185
v_max3_f32 v185, v90, v91, v185
v_max3_f32 v185, v92, v93, v185
v_max3_f32 v185, v94, v95, v185
v_max3_f32 v185, v96, v97, v185
v_max3_f32 v185, v98, v99, v185
v_max3_f32 v185, v100, v101, v185
v_max3_f32 v185, v102, v103, v185
s_waitcnt lgkmcnt(0)
v_mfma_f32_32x32x16_bf16 v[56:71], a[4:7], a[128:131], v[136:151]
v_mfma_f32_32x32x16_bf16 v[88:103], a[4:7], a[132:135], v[136:151]
ds_read_b128 a[0:3], v27 offset:4096
v_max3_f32 v184, v40, v41, v184
v_max3_f32 v184, v42, v43, v184
v_max3_f32 v184, v44, v45, v184
v_max3_f32 v184, v46, v47, v184
v_max3_f32 v184, v48, v49, v184
v_max3_f32 v184, v50, v51, v184
v_max3_f32 v184, v52, v53, v184
v_max3_f32 v184, v54, v55, v184
v_max3_f32 v185, v72, v73, v185
v_max3_f32 v185, v74, v75, v185
v_max3_f32 v185, v76, v77, v185
v_max3_f32 v185, v78, v79, v185
v_max3_f32 v185, v80, v81, v185
v_max3_f32 v185, v82, v83, v185
v_max3_f32 v185, v84, v85, v185
v_max3_f32 v185, v86, v87, v185
s_cmp_lg_u32 s46, 4
s_cbranch_scc1 tv_30
v_mov_b32 v136, 0
v_mov_b32 v137, 0
v_mov_b32 v138, 0
v_mov_b32 v139, 0
v_mov_b32 v140, 0
v_mov_b32 v141, 0
v_mov_b32 v142, 0
v_mov_b32 v143, 0
v_mov_b32 v144, 0
v_mov_b32 v145, 0
v_mov_b32 v146, 0
v_mov_b32 v147, 0
v_mov_b32 v148, 0
v_mov_b32 v149, 0
v_mov_b32 v150, 0
v_mov_b32 v151, 0
tv_30:
s_waitcnt lgkmcnt(0)
s_nop 0
v_mfma_f32_32x32x16_bf16 v[40:55], a[0:3], a[128:131], v[136:151]
v_mfma_f32_32x32x16_bf16 v[72:87], a[0:3], a[132:135], v[136:151]
ds_read_b128 a[4:7], v27 offset:5120
v_max3_f32 v184, v56, v57, v184
v_max3_f32 v184, v58, v59, v184
v_max3_f32 v184, v60, v61, v184
v_max3_f32 v184, v62, v63, v184
v_max3_f32 v184, v64, v65, v184
v_max3_f32 v184, v66, v67, v184
v_max3_f32 v184, v68, v69, v184
v_max3_f32 v184, v70, v71, v184
v_max3_f32 v185, v88, v89, v185
v_max3_f32 v185, v90, v91, v185
v_max3_f32 v185, v92, v93, v185
v_max3_f32 v185, v94, v95, v185
v_max3_f32 v185, v96, v97, v185
v_max3_f32 v185, v98, v99, v185
v_max3_f32 v185, v100, v101, v185
v_max3_f32 v185, v102, v103, v185
s_waitcnt lgkmcnt(0)
v_mfma_f32_32x32x16_bf16 v[56:71], a[4:7], a[128:131], v[136:151]
v_mfma_f32_32x32x16_bf16 v[88:103], a[4:7], a[132:135], v[136:151]
ds_read_b128 a[0:3], v27 offset:6144
v_max3_f32 v184, v40, v41, v184
v_max3_f32 v184, v42, v43, v184
v_max3_f32 v184, v44, v45, v184
v_max3_f32 v184, v46, v47, v184
v_max3_f32 v184, v48, v49, v184
v_max3_f32 v184, v50, v51, v184
v_max3_f32 v184, v52, v53, v184
v_max3_f32 v184, v54, v55, v184
v_max3_f32 v185, v72, v73, v185
v_max3_f32 v185, v74, v75, v185
v_max3_f32 v185, v76, v77, v185
v_max3_f32 v185, v78, v79, v185
v_max3_f32 v185, v80, v81, v185
v_max3_f32 v185, v82, v83, v185
v_max3_f32 v185, v84, v85, v185
v_max3_f32 v185, v86, v87, v185
s_cmp_lg_u32 s46, 6
s_cbranch_scc1 tv_31
v_mov_b32 v136, 0
v_mov_b32 v137, 0
v_mov_b32 v138, 0
v_mov_b32 v139, 0
v_mov_b32 v140, 0
v_mov_b32 v141, 0
v_mov_b32 v142, 0
v_mov_b32 v143, 0
v_mov_b32 v144, 0
v_mov_b32 v145, 0
v_mov_b32 v146, 0
v_mov_b32 v147, 0
v_mov_b32 v148, 0
v_mov_b32 v149, 0
v_mov_b32 v150, 0
v_mov_b32 v151, 0
tv_31:
s_waitcnt lgkmcnt(0)
s_nop 0
v_mfma_f32_32x32x16_bf16 v[40:55], a[0:3], a[128:131], v[136:151]
v_mfma_f32_32x32x16_bf16 v[72:87], a[0:3], a[132:135], v[136:151]
ds_read_b128 a[4:7], v27 offset:7168
v_max3_f32 v184, v56, v57, v184
v_max3_f32 v184, v58, v59, v184
v_max3_f32 v184, v60, v61, v184
v_max3_f32 v184, v62, v63, v184
v_max3_f32 v184, v64, v65, v184
v_max3_f32 v184, v66, v67, v184
v_max3_f32 v184, v68, v69, v184
v_max3_f32 v184, v70, v71, v184
v_max3_f32 v185, v88, v89, v185
v_max3_f32 v185, v90, v91, v185
v_max3_f32 v185, v92, v93, v185
v_max3_f32 v185, v94, v95, v185
v_max3_f32 v185, v96, v97, v185
v_max3_f32 v185, v98, v99, v185
v_max3_f32 v185, v100, v101, v185
v_max3_f32 v185, v102, v103, v185
s_waitcnt lgkmcnt(0)
v_mfma_f32_32x32x16_bf16 v[56:71], a[4:7], a[128:131], v[136:151]
v_mfma_f32_32x32x16_bf16 v[88:103], a[4:7], a[132:135], v[136:151]
ds_read_b128 a[0:3], v27 offset:8192
v_max3_f32 v184, v40, v41, v184
v_max3_f32 v184, v42, v43, v184
v_max3_f32 v184, v44, v45, v184
v_max3_f32 v184, v46, v47, v184
v_max3_f32 v184, v48, v49, v184
v_max3_f32 v184, v50, v51, v184
v_max3_f32 v184, v52, v53, v184
v_max3_f32 v184, v54, v55, v184
v_max3_f32 v185, v72, v73, v185
v_max3_f32 v185, v74, v75, v185
v_max3_f32 v185, v76, v77, v185
v_max3_f32 v185, v78, v79, v185
v_max3_f32 v185, v80, v81, v185
v_max3_f32 v185, v82, v83, v185
v_max3_f32 v185, v84, v85, v185
v_max3_f32 v185, v86, v87, v185
s_cmp_lg_u32 s46, 8
s_cbranch_scc1 tv_32
v_mov_b32 v136, 0
v_mov_b32 v137, 0
v_mov_b32 v138, 0
v_mov_b32 v139, 0
v_mov_b32 v140, 0
v_mov_b32 v141, 0
v_mov_b32 v142, 0
v_mov_b32 v143, 0
v_mov_b32 v144, 0
v_mov_b32 v145, 0
v_mov_b32 v146, 0
v_mov_b32 v147, 0
v_mov_b32 v148, 0
v_mov_b32 v149, 0
v_mov_b32 v150, 0
v_mov_b32 v151, 0
tv_32:
s_waitcnt lgkmcnt(0)
v_mfma_f32_32x32x16_bf16 v[40:55], a[0:3], a[128:131], v[120:135]
v_mfma_f32_32x32x16_bf16 v[72:87], a[0:3], a[132:135], v[136:151]
ds_read_b128 a[4:7], v27 offset:9216
v_max3_f32 v184, v56, v57, v184
v_max3_f32 v184, v58, v59, v184
v_max3_f32 v184, v60, v61, v184
v_max3_f32 v184, v62, v63, v184
v_max3_f32 v184, v64, v65, v184
v_max3_f32 v184, v66, v67, v184
v_max3_f32 v184, v68, v69, v184
v_max3_f32 v184, v70, v71, v184
v_max3_f32 v185, v88, v89, v185
v_max3_f32 v185, v90, v91, v185
v_max3_f32 v185, v92, v93, v185
v_max3_f32 v185, v94, v95, v185
v_max3_f32 v185, v96, v97, v185
v_max3_f32 v185, v98, v99, v185
v_max3_f32 v185, v100, v101, v185
v_max3_f32 v185, v102, v103, v185
s_waitcnt lgkmcnt(0)
v_mfma_f32_32x32x16_bf16 v[88:103], a[4:7], a[132:135], v[120:135]
v_max3_f32 v184, v40, v41, v184
v_max3_f32 v184, v42, v43, v184
v_max3_f32 v184, v44, v45, v184
v_max3_f32 v184, v46, v47, v184
v_max3_f32 v184, v48, v49, v184
v_max3_f32 v184, v50, v51, v184
v_max3_f32 v184, v52, v53, v184
v_max3_f32 v184, v54, v55, v184
v_max3_f32 v185, v72, v73, v185
v_max3_f32 v185, v74, v75, v185
v_max3_f32 v185, v76, v77, v185
v_max3_f32 v185, v78, v79, v185
v_max3_f32 v185, v80, v81, v185
v_max3_f32 v185, v82, v83, v185
v_max3_f32 v185, v84, v85, v185
v_max3_f32 v185, v86, v87, v185
v_max3_f32 v185, v88, v89, v185
v_max3_f32 v185, v90, v91, v185
v_max3_f32 v185, v92, v93, v185
v_max3_f32 v185, v94, v95, v185
v_max3_f32 v185, v96, v97, v185
v_max3_f32 v185, v98, v99, v185
v_max3_f32 v185, v100, v101, v185
v_max3_f32 v185, v102, v103, v185
v_mov_b32 v32, v184
s_nop 1
v_permlane32_swap_b32 v184, v32
v_max_f32 v184, v184, v32
v_sub_f32 v184, 0, v184
v_mov_b32 v32, v185
s_nop 1
v_permlane32_swap_b32 v185, v32
v_max_f32 v185, v185, v32
v_sub_f32 v185, 0, v185
s_cmp_lg_u32 s46, 0
s_cselect_b64 s[24:25], -1, 0
v_mov_b32 v34, 0xf149f2ca
v_cndmask_b32 v35, v184, v34, s[24:25]
v_cndmask_b32 v36, v185, v34, s[24:25]
v_mov_b32 v104, v35
v_mov_b32 v120, v36
v_mov_b32 v105, v35
v_mov_b32 v121, v36
v_mov_b32 v106, v35
v_mov_b32 v122, v36
v_mov_b32 v107, v35
v_mov_b32 v123, v36
v_mov_b32 v108, v35
v_mov_b32 v124, v36
v_mov_b32 v109, v35
v_mov_b32 v125, v36
v_mov_b32 v110, v35
v_mov_b32 v126, v36
v_mov_b32 v111, v35
v_mov_b32 v127, v36
v_mov_b32 v112, v35
v_mov_b32 v128, v36
v_mov_b32 v113, v35
v_mov_b32 v129, v36
v_mov_b32 v114, v35
v_mov_b32 v130, v36
v_mov_b32 v115, v35
v_mov_b32 v131, v36
v_mov_b32 v116, v35
v_mov_b32 v132, v36
v_mov_b32 v117, v35
v_mov_b32 v133, v36
v_mov_b32 v118, v35
v_mov_b32 v134, v36
v_mov_b32 v119, v35
v_mov_b32 v135, v36
ds_read_b128 a[0:3], v27 offset:0
s_waitcnt lgkmcnt(0)
v_mfma_f32_32x32x16_bf16 v[40:55], a[0:3], a[128:131], v[104:119]
ds_read_b128 a[4:7], v27 offset:1024
ds_read_b64_tr_b16 a[8:9], v28 offset:0
ds_read_b64_tr_b16 a[10:11], v28 offset:256
ds_read_b64_tr_b16 a[12:13], v28 offset:512
ds_read_b64_tr_b16 a[14:15], v28 offset:768
v_add_u32 v28, v28, v29
s_waitcnt lgkmcnt(0)
v_mfma_f32_32x32x16_bf16 v[56:71], a[4:7], a[128:131], v[104:119]
v_mfma_f32_32x32x16_bf16 v[88:103], a[4:7], a[132:135], v[120:135]
ds_read_b128 a[0:3], v27 offset:2048
ds_read_b64_tr_b16 a[16:17], v28 offset:0
ds_read_b64_tr_b16 a[18:19], v28 offset:256
ds_read_b64_tr_b16 a[20:21], v28 offset:512
ds_read_b64_tr_b16 a[22:23], v28 offset:768
v_add_u32 v28, v28, v29
v_exp_f32 v40, v40
v_exp_f32 v41, v41
v_exp_f32 v42, v42
v_exp_f32 v43, v43
v_exp_f32 v44, v44
v_exp_f32 v45, v45
v_exp_f32 v46, v46
v_exp_f32 v47, v47
v_exp_f32 v48, v48
v_exp_f32 v49, v49
v_exp_f32 v50, v50
v_exp_f32 v51, v51
v_exp_f32 v52, v52
v_exp_f32 v53, v53
v_exp_f32 v54, v54
v_exp_f32 v55, v55
v_cvt_pk_bf16_f32 v168, v40, v41
v_cvt_pk_bf16_f32 v169, v42, v43
v_cvt_pk_bf16_f32 v170, v44, v45
v_cvt_pk_bf16_f32 v171, v46, v47
v_cvt_pk_bf16_f32 v172, v48, v49
v_cvt_pk_bf16_f32 v173, v50, v51
v_cvt_pk_bf16_f32 v174, v52, v53
v_cvt_pk_bf16_f32 v175, v54, v55
v_and_b32 v168, v168, v152
v_and_b32 v169, v169, v153
v_and_b32 v170, v170, v154
v_and_b32 v171, v171, v155
v_and_b32 v172, v172, v156
v_and_b32 v173, v173, v157
v_and_b32 v174, v174, v158
v_and_b32 v175, v175, v159
v_mfma_f32_32x32x16_bf16 a[32:47], a[8:11], v[168:171], 0
s_nop 0
v_mfma_f32_32x32x16_bf16 a[32:47], a[12:15], v[172:175], a[32:47]
s_cmp_lg_u32 s46, 2
s_cbranch_scc1 tv_33
v_mov_b32 v104, v184
v_mov_b32 v105, v184
v_mov_b32 v106, v184
v_mov_b32 v107, v184
v_mov_b32 v108, v184
v_mov_b32 v109, v184
v_mov_b32 v110, v184
v_mov_b32 v111, v184
v_mov_b32 v112, v184
v_mov_b32 v113, v184
v_mov_b32 v114, v184
v_mov_b32 v115, v184
v_mov_b32 v116, v184
v_mov_b32 v117, v184
v_mov_b32 v118, v184
v_mov_b32 v119, v184
v_mov_b32 v120, v185
v_mov_b32 v121, v185
v_mov_b32 v122, v185
v_mov_b32 v123, v185
v_mov_b32 v124, v185
v_mov_b32 v125, v185
v_mov_b32 v126, v185
v_mov_b32 v127, v185
v_mov_b32 v128, v185
v_mov_b32 v129, v185
v_mov_b32 v130, v185
v_mov_b32 v131, v185
v_mov_b32 v132, v185
v_mov_b32 v133, v185
v_mov_b32 v134, v185
v_mov_b32 v135, v185
tv_33:
s_waitcnt lgkmcnt(0)
s_nop 0
v_mfma_f32_32x32x16_bf16 v[40:55], a[0:3], a[128:131], v[104:119]
v_mfma_f32_32x32x16_bf16 v[72:87], a[0:3], a[132:135], v[120:135]
ds_read_b128 a[4:7], v27 offset:3072
ds_read_b64_tr_b16 a[24:25], v28 offset:0
ds_read_b64_tr_b16 a[26:27], v28 offset:256
ds_read_b64_tr_b16 a[28:29], v28 offset:512
ds_read_b64_tr_b16 a[30:31], v28 offset:768
v_add_u32 v28, v28, v29
v_exp_f32 v56, v56
v_exp_f32 v57, v57
v_exp_f32 v58, v58
v_exp_f32 v59, v59
v_exp_f32 v60, v60
v_exp_f32 v61, v61
v_exp_f32 v62, v62
v_exp_f32 v63, v63
v_exp_f32 v64, v64
v_exp_f32 v65, v65
v_exp_f32 v66, v66
v_exp_f32 v67, v67
v_exp_f32 v68, v68
v_exp_f32 v69, v69
v_exp_f32 v70, v70
v_exp_f32 v71, v71
v_cvt_pk_bf16_f32 v168, v56, v57
v_cvt_pk_bf16_f32 v169, v58, v59
v_cvt_pk_bf16_f32 v170, v60, v61
v_cvt_pk_bf16_f32 v171, v62, v63
v_cvt_pk_bf16_f32 v172, v64, v65
v_cvt_pk_bf16_f32 v173, v66, v67
v_cvt_pk_bf16_f32 v174, v68, v69
v_cvt_pk_bf16_f32 v175, v70, v71
v_mfma_f32_32x32x16_bf16 a[32:47], a[16:19], v[168:171], a[32:47]
s_nop 0
v_mfma_f32_32x32x16_bf16 a[32:47], a[20:23], v[172:175], a[32:47]
v_exp_f32 v88, v88
v_exp_f32 v89, v89
v_exp_f32 v90, v90
v_exp_f32 v91, v91
v_exp_f32 v92, v92
v_exp_f32 v93, v93
v_exp_f32 v94, v94
v_exp_f32 v95, v95
v_exp_f32 v96, v96
v_exp_f32 v97, v97
v_exp_f32 v98, v98
v_exp_f32 v99, v99
v_exp_f32 v100, v100
v_exp_f32 v101, v101
v_exp_f32 v102, v102
v_exp_f32 v103, v103
v_cvt_pk_bf16_f32 v176, v88, v89
v_cvt_pk_bf16_f32 v177, v90, v91
v_cvt_pk_bf16_f32 v178, v92, v93
v_cvt_pk_bf16_f32 v179, v94, v95
v_cvt_pk_bf16_f32 v180, v96, v97
v_cvt_pk_bf16_f32 v181, v98, v99
v_cvt_pk_bf16_f32 v182, v100, v101
v_cvt_pk_bf16_f32 v183, v102, v103
v_and_b32 v176, v176, v152
v_and_b32 v177, v177, v153
v_and_b32 v178, v178, v154
v_and_b32 v179, v179, v155
v_and_b32 v180, v180, v156
v_and_b32 v181, v181, v157
v_and_b32 v182, v182, v158
v_and_b32 v183, v183, v159
v_mfma_f32_32x32x16_bf16 a[48:63], a[16:19], v[176:179], 0
s_nop 0
v_mfma_f32_32x32x16_bf16 a[48:63], a[20:23], v[180:183], a[48:63]
s_waitcnt lgkmcnt(0)
v_mfma_f32_32x32x16_bf16 v[56:71], a[4:7], a[128:131], v[104:119]
v_mfma_f32_32x32x16_bf16 v[88:103], a[4:7], a[132:135], v[120:135]
ds_read_b128 a[0:3], v27 offset:4096
ds_read_b64_tr_b16 a[8:9], v28 offset:0
ds_read_b64_tr_b16 a[10:11], v28 offset:256
ds_read_b64_tr_b16 a[12:13], v28 offset:512
ds_read_b64_tr_b16 a[14:15], v28 offset:768
v_add_u32 v28, v28, v29
v_exp_f32 v40, v40
v_exp_f32 v41, v41
v_exp_f32 v42, v42
v_exp_f32 v43, v43
v_exp_f32 v44, v44
v_exp_f32 v45, v45
v_exp_f32 v46, v46
v_exp_f32 v47, v47
v_exp_f32 v48, v48
v_exp_f32 v49, v49
v_exp_f32 v50, v50
v_exp_f32 v51, v51
v_exp_f32 v52, v52
v_exp_f32 v53, v53
v_exp_f32 v54, v54
v_exp_f32 v55, v55
v_cvt_pk_bf16_f32 v168, v40, v41
v_cvt_pk_bf16_f32 v169, v42, v43
v_cvt_pk_bf16_f32 v170, v44, v45
v_cvt_pk_bf16_f32 v171, v46, v47
v_cvt_pk_bf16_f32 v172, v48, v49
v_cvt_pk_bf16_f32 v173, v50, v51
v_cvt_pk_bf16_f32 v174, v52, v53
v_cvt_pk_bf16_f32 v175, v54, v55
v_mfma_f32_32x32x16_bf16 a[32:47], a[24:27], v[168:171], a[32:47]
s_nop 0
v_mfma_f32_32x32x16_bf16 a[32:47], a[28:31], v[172:175], a[32:47]
v_exp_f32 v72, v72
v_exp_f32 v73, v73
v_exp_f32 v74, v74
v_exp_f32 v75, v75
v_exp_f32 v76, v76
v_exp_f32 v77, v77
v_exp_f32 v78, v78
v_exp_f32 v79, v79
v_exp_f32 v80, v80
v_exp_f32 v81, v81
v_exp_f32 v82, v82
v_exp_f32 v83, v83
v_exp_f32 v84, v84
v_exp_f32 v85, v85
v_exp_f32 v86, v86
v_exp_f32 v87, v87
v_cvt_pk_bf16_f32 v176, v72, v73
v_cvt_pk_bf16_f32 v177, v74, v75
v_cvt_pk_bf16_f32 v178, v76, v77
v_cvt_pk_bf16_f32 v179, v78, v79
v_cvt_pk_bf16_f32 v180, v80, v81
v_cvt_pk_bf16_f32 v181, v82, v83
v_cvt_pk_bf16_f32 v182, v84, v85
v_cvt_pk_bf16_f32 v183, v86, v87
v_mfma_f32_32x32x16_bf16 a[48:63], a[24:27], v[176:179], a[48:63]
s_nop 0
v_mfma_f32_32x32x16_bf16 a[48:63], a[28:31], v[180:183], a[48:63]
s_cmp_lg_u32 s46, 4
s_cbranch_scc1 tv_34
v_mov_b32 v104, v184
v_mov_b32 v105, v184
v_mov_b32 v106, v184
v_mov_b32 v107, v184
v_mov_b32 v108, v184
v_mov_b32 v109, v184
v_mov_b32 v110, v184
v_mov_b32 v111, v184
v_mov_b32 v112, v184
v_mov_b32 v113, v184
v_mov_b32 v114, v184
v_mov_b32 v115, v184
v_mov_b32 v116, v184
v_mov_b32 v117, v184
v_mov_b32 v118, v184
v_mov_b32 v119, v184
v_mov_b32 v120, v185
v_mov_b32 v121, v185
v_mov_b32 v122, v185
v_mov_b32 v123, v185
v_mov_b32 v124, v185
v_mov_b32 v125, v185
v_mov_b32 v126, v185
v_mov_b32 v127, v185
v_mov_b32 v128, v185
v_mov_b32 v129, v185
v_mov_b32 v130, v185
v_mov_b32 v131, v185
v_mov_b32 v132, v185
v_mov_b32 v133, v185
v_mov_b32 v134, v185
v_mov_b32 v135, v185
tv_34:
s_waitcnt lgkmcnt(0)
s_nop 0
v_mfma_f32_32x32x16_bf16 v[40:55], a[0:3], a[128:131], v[104:119]
v_mfma_f32_32x32x16_bf16 v[72:87], a[0:3], a[132:135], v[120:135]
ds_read_b128 a[4:7], v27 offset:5120
ds_read_b64_tr_b16 a[16:17], v28 offset:0
ds_read_b64_tr_b16 a[18:19], v28 offset:256
ds_read_b64_tr_b16 a[20:21], v28 offset:512
ds_read_b64_tr_b16 a[22:23], v28 offset:768
v_add_u32 v28, v28, v29
v_exp_f32 v56, v56
v_exp_f32 v57, v57
v_exp_f32 v58, v58
v_exp_f32 v59, v59
v_exp_f32 v60, v60
v_exp_f32 v61, v61
v_exp_f32 v62, v62
v_exp_f32 v63, v63
v_exp_f32 v64, v64
v_exp_f32 v65, v65
v_exp_f32 v66, v66
v_exp_f32 v67, v67
v_exp_f32 v68, v68
v_exp_f32 v69, v69
v_exp_f32 v70, v70
v_exp_f32 v71, v71
v_cvt_pk_bf16_f32 v168, v56, v57
v_cvt_pk_bf16_f32 v169, v58, v59
v_cvt_pk_bf16_f32 v170, v60, v61
v_cvt_pk_bf16_f32 v171, v62, v63
v_cvt_pk_bf16_f32 v172, v64, v65
v_cvt_pk_bf16_f32 v173, v66, v67
v_cvt_pk_bf16_f32 v174, v68, v69
v_cvt_pk_bf16_f32 v175, v70, v71
v_mfma_f32_32x32x16_bf16 a[32:47], a[8:11], v[168:171], a[32:47]
s_nop 0
v_mfma_f32_32x32x16_bf16 a[32:47], a[12:15], v[172:175], a[32:47]
v_exp_f32 v88, v88
v_exp_f32 v89, v89
v_exp_f32 v90, v90
v_exp_f32 v91, v91
v_exp_f32 v92, v92
v_exp_f32 v93, v93
v_exp_f32 v94, v94
v_exp_f32 v95, v95
v_exp_f32 v96, v96
v_exp_f32 v97, v97
v_exp_f32 v98, v98
v_exp_f32 v99, v99
v_exp_f32 v100, v100
v_exp_f32 v101, v101
v_exp_f32 v102, v102
v_exp_f32 v103, v103
v_cvt_pk_bf16_f32 v176, v88, v89
v_cvt_pk_bf16_f32 v177, v90, v91
v_cvt_pk_bf16_f32 v178, v92, v93
v_cvt_pk_bf16_f32 v179, v94, v95
v_cvt_pk_bf16_f32 v180, v96, v97
v_cvt_pk_bf16_f32 v181, v98, v99
v_cvt_pk_bf16_f32 v182, v100, v101
v_cvt_pk_bf16_f32 v183, v102, v103
v_mfma_f32_32x32x16_bf16 a[48:63], a[8:11], v[176:179], a[48:63]
s_nop 0
v_mfma_f32_32x32x16_bf16 a[48:63], a[12:15], v[180:183], a[48:63]
s_waitcnt lgkmcnt(0)
v_mfma_f32_32x32x16_bf16 v[56:71], a[4:7], a[128:131], v[104:119]
v_mfma_f32_32x32x16_bf16 v[88:103], a[4:7], a[132:135], v[120:135]
ds_read_b128 a[0:3], v27 offset:6144
ds_read_b64_tr_b16 a[24:25], v28 offset:0
ds_read_b64_tr_b16 a[26:27], v28 offset:256
ds_read_b64_tr_b16 a[28:29], v28 offset:512
ds_read_b64_tr_b16 a[30:31], v28 offset:768
v_add_u32 v28, v28, v29
v_exp_f32 v40, v40
v_exp_f32 v41, v41
v_exp_f32 v42, v42
v_exp_f32 v43, v43
v_exp_f32 v44, v44
v_exp_f32 v45, v45
v_exp_f32 v46, v46
v_exp_f32 v47, v47
v_exp_f32 v48, v48
v_exp_f32 v49, v49
v_exp_f32 v50, v50
v_exp_f32 v51, v51
v_exp_f32 v52, v52
v_exp_f32 v53, v53
v_exp_f32 v54, v54
v_exp_f32 v55, v55
v_cvt_pk_bf16_f32 v168, v40, v41
v_cvt_pk_bf16_f32 v169, v42, v43
v_cvt_pk_bf16_f32 v170, v44, v45
v_cvt_pk_bf16_f32 v171, v46, v47
v_cvt_pk_bf16_f32 v172, v48, v49
v_cvt_pk_bf16_f32 v173, v50, v51
v_cvt_pk_bf16_f32 v174, v52, v53
v_cvt_pk_bf16_f32 v175, v54, v55
v_mfma_f32_32x32x16_bf16 a[32:47], a[16:19], v[168:171], a[32:47]
s_nop 0
v_mfma_f32_32x32x16_bf16 a[32:47], a[20:23], v[172:175], a[32:47]
v_exp_f32 v72, v72
v_exp_f32 v73, v73
v_exp_f32 v74, v74
v_exp_f32 v75, v75
v_exp_f32 v76, v76
v_exp_f32 v77, v77
v_exp_f32 v78, v78
v_exp_f32 v79, v79
v_exp_f32 v80, v80
v_exp_f32 v81, v81
v_exp_f32 v82, v82
v_exp_f32 v83, v83
v_exp_f32 v84, v84
v_exp_f32 v85, v85
v_exp_f32 v86, v86
v_exp_f32 v87, v87
v_cvt_pk_bf16_f32 v176, v72, v73
v_cvt_pk_bf16_f32 v177, v74, v75
v_cvt_pk_bf16_f32 v178, v76, v77
v_cvt_pk_bf16_f32 v179, v78, v79
v_cvt_pk_bf16_f32 v180, v80, v81
v_cvt_pk_bf16_f32 v181, v82, v83
v_cvt_pk_bf16_f32 v182, v84, v85
v_cvt_pk_bf16_f32 v183, v86, v87
v_mfma_f32_32x32x16_bf16 a[48:63], a[16:19], v[176:179], a[48:63]
s_nop 0
v_mfma_f32_32x32x16_bf16 a[48:63], a[20:23], v[180:183], a[48:63]
s_cmp_lg_u32 s46, 6
s_cbranch_scc1 tv_35
v_mov_b32 v104, v184
v_mov_b32 v105, v184
v_mov_b32 v106, v184
v_mov_b32 v107, v184
v_mov_b32 v108, v184
v_mov_b32 v109, v184
v_mov_b32 v110, v184
v_mov_b32 v111, v184
v_mov_b32 v112, v184
v_mov_b32 v113, v184
v_mov_b32 v114, v184
v_mov_b32 v115, v184
v_mov_b32 v116, v184
v_mov_b32 v117, v184
v_mov_b32 v118, v184
v_mov_b32 v119, v184
v_mov_b32 v120, v185
v_mov_b32 v121, v185
v_mov_b32 v122, v185
v_mov_b32 v123, v185
v_mov_b32 v124, v185
v_mov_b32 v125, v185
v_mov_b32 v126, v185
v_mov_b32 v127, v185
v_mov_b32 v128, v185
v_mov_b32 v129, v185
v_mov_b32 v130, v185
v_mov_b32 v131, v185
v_mov_b32 v132, v185
v_mov_b32 v133, v185
v_mov_b32 v134, v185
v_mov_b32 v135, v185
tv_35:
s_waitcnt lgkmcnt(0)
s_nop 0
v_mfma_f32_32x32x16_bf16 v[40:55], a[0:3], a[128:131], v[104:119]
v_mfma_f32_32x32x16_bf16 v[72:87], a[0:3], a[132:135], v[120:135]
ds_read_b128 a[4:7], v27 offset:7168
ds_read_b64_tr_b16 a[8:9], v28 offset:0
ds_read_b64_tr_b16 a[10:11], v28 offset:256
ds_read_b64_tr_b16 a[12:13], v28 offset:512
ds_read_b64_tr_b16 a[14:15], v28 offset:768
v_add_u32 v28, v28, v29
v_exp_f32 v56, v56
v_exp_f32 v57, v57
v_exp_f32 v58, v58
v_exp_f32 v59, v59
v_exp_f32 v60, v60
v_exp_f32 v61, v61
v_exp_f32 v62, v62
v_exp_f32 v63, v63
v_exp_f32 v64, v64
v_exp_f32 v65, v65
v_exp_f32 v66, v66
v_exp_f32 v67, v67
v_exp_f32 v68, v68
v_exp_f32 v69, v69
v_exp_f32 v70, v70
v_exp_f32 v71, v71
v_cvt_pk_bf16_f32 v168, v56, v57
v_cvt_pk_bf16_f32 v169, v58, v59
v_cvt_pk_bf16_f32 v170, v60, v61
v_cvt_pk_bf16_f32 v171, v62, v63
v_cvt_pk_bf16_f32 v172, v64, v65
v_cvt_pk_bf16_f32 v173, v66, v67
v_cvt_pk_bf16_f32 v174, v68, v69
v_cvt_pk_bf16_f32 v175, v70, v71
v_mfma_f32_32x32x16_bf16 a[32:47], a[24:27], v[168:171], a[32:47]
s_nop 0
v_mfma_f32_32x32x16_bf16 a[32:47], a[28:31], v[172:175], a[32:47]
v_exp_f32 v88, v88
v_exp_f32 v89, v89
v_exp_f32 v90, v90
v_exp_f32 v91, v91
v_exp_f32 v92, v92
v_exp_f32 v93, v93
v_exp_f32 v94, v94
v_exp_f32 v95, v95
v_exp_f32 v96, v96
v_exp_f32 v97, v97
v_exp_f32 v98, v98
v_exp_f32 v99, v99
v_exp_f32 v100, v100
v_exp_f32 v101, v101
v_exp_f32 v102, v102
v_exp_f32 v103, v103
v_cvt_pk_bf16_f32 v176, v88, v89
v_cvt_pk_bf16_f32 v177, v90, v91
v_cvt_pk_bf16_f32 v178, v92, v93
v_cvt_pk_bf16_f32 v179, v94, v95
v_cvt_pk_bf16_f32 v180, v96, v97
v_cvt_pk_bf16_f32 v181, v98, v99
v_cvt_pk_bf16_f32 v182, v100, v101
v_cvt_pk_bf16_f32 v183, v102, v103
v_mfma_f32_32x32x16_bf16 a[48:63], a[24:27], v[176:179], a[48:63]
s_nop 0
v_mfma_f32_32x32x16_bf16 a[48:63], a[28:31], v[180:183], a[48:63]
s_waitcnt lgkmcnt(0)
v_mfma_f32_32x32x16_bf16 v[56:71], a[4:7], a[128:131], v[104:119]
v_mfma_f32_32x32x16_bf16 v[88:103], a[4:7], a[132:135], v[120:135]
ds_read_b128 a[0:3], v27 offset:8192
ds_read_b64_tr_b16 a[16:17], v28 offset:0
ds_read_b64_tr_b16 a[18:19], v28 offset:256
ds_read_b64_tr_b16 a[20:21], v28 offset:512
ds_read_b64_tr_b16 a[22:23], v28 offset:768
v_add_u32 v28, v28, v29
v_exp_f32 v40, v40
v_exp_f32 v41, v41
v_exp_f32 v42, v42
v_exp_f32 v43, v43
v_exp_f32 v44, v44
v_exp_f32 v45, v45
v_exp_f32 v46, v46
v_exp_f32 v47, v47
v_exp_f32 v48, v48
v_exp_f32 v49, v49
v_exp_f32 v50, v50
v_exp_f32 v51, v51
v_exp_f32 v52, v52
v_exp_f32 v53, v53
v_exp_f32 v54, v54
v_exp_f32 v55, v55
v_cvt_pk_bf16_f32 v168, v40, v41
v_cvt_pk_bf16_f32 v169, v42, v43
v_cvt_pk_bf16_f32 v170, v44, v45
v_cvt_pk_bf16_f32 v171, v46, v47
v_cvt_pk_bf16_f32 v172, v48, v49
v_cvt_pk_bf16_f32 v173, v50, v51
v_cvt_pk_bf16_f32 v174, v52, v53
v_cvt_pk_bf16_f32 v175, v54, v55
v_mfma_f32_32x32x16_bf16 a[32:47], a[8:11], v[168:171], a[32:47]
s_nop 0
v_mfma_f32_32x32x16_bf16 a[32:47], a[12:15], v[172:175], a[32:47]
v_exp_f32 v72, v72
v_exp_f32 v73, v73
v_exp_f32 v74, v74
v_exp_f32 v75, v75
v_exp_f32 v76, v76
v_exp_f32 v77, v77
v_exp_f32 v78, v78
v_exp_f32 v79, v79
v_exp_f32 v80, v80
v_exp_f32 v81, v81
v_exp_f32 v82, v82
v_exp_f32 v83, v83
v_exp_f32 v84, v84
v_exp_f32 v85, v85
v_exp_f32 v86, v86
v_exp_f32 v87, v87
v_cvt_pk_bf16_f32 v176, v72, v73
v_cvt_pk_bf16_f32 v177, v74, v75
v_cvt_pk_bf16_f32 v178, v76, v77
v_cvt_pk_bf16_f32 v179, v78, v79
v_cvt_pk_bf16_f32 v180, v80, v81
v_cvt_pk_bf16_f32 v181, v82, v83
v_cvt_pk_bf16_f32 v182, v84, v85
v_cvt_pk_bf16_f32 v183, v86, v87
v_mfma_f32_32x32x16_bf16 a[48:63], a[8:11], v[176:179], a[48:63]
s_nop 0
v_mfma_f32_32x32x16_bf16 a[48:63], a[12:15], v[180:183], a[48:63]
s_cmp_lg_u32 s46, 8
s_cbranch_scc1 tv_36
v_mov_b32 v104, v184
v_mov_b32 v105, v184
v_mov_b32 v106, v184
v_mov_b32 v107, v184
v_mov_b32 v108, v184
v_mov_b32 v109, v184
v_mov_b32 v110, v184
v_mov_b32 v111, v184
v_mov_b32 v112, v184
v_mov_b32 v113, v184
v_mov_b32 v114, v184
v_mov_b32 v115, v184
v_mov_b32 v116, v184
v_mov_b32 v117, v184
v_mov_b32 v118, v184
v_mov_b32 v119, v184
v_mov_b32 v120, v185
v_mov_b32 v121, v185
v_mov_b32 v122, v185
v_mov_b32 v123, v185
v_mov_b32 v124, v185
v_mov_b32 v125, v185
v_mov_b32 v126, v185
v_mov_b32 v127, v185
v_mov_b32 v128, v185
v_mov_b32 v129, v185
v_mov_b32 v130, v185
v_mov_b32 v131, v185
v_mov_b32 v132, v185
v_mov_b32 v133, v185
v_mov_b32 v134, v185
v_mov_b32 v135, v185
tv_36:
s_waitcnt lgkmcnt(0)
s_nop 0
v_mfma_f32_32x32x16_bf16 v[40:55], a[0:3], a[128:131], v[104:119]
v_mfma_f32_32x32x16_bf16 v[72:87], a[0:3], a[132:135], v[120:135]
ds_read_b128 a[4:7], v27 offset:9216
ds_read_b64_tr_b16 a[24:25], v28 offset:0
ds_read_b64_tr_b16 a[26:27], v28 offset:256
ds_read_b64_tr_b16 a[28:29], v28 offset:512
ds_read_b64_tr_b16 a[30:31], v28 offset:768
v_add_u32 v28, v28, v29
v_exp_f32 v56, v56
v_exp_f32 v57, v57
v_exp_f32 v58, v58
v_exp_f32 v59, v59
v_exp_f32 v60, v60
v_exp_f32 v61, v61
v_exp_f32 v62, v62
v_exp_f32 v63, v63
v_exp_f32 v64, v64
v_exp_f32 v65, v65
v_exp_f32 v66, v66
v_exp_f32 v67, v67
v_exp_f32 v68, v68
v_exp_f32 v69, v69
v_exp_f32 v70, v70
v_exp_f32 v71, v71
v_cvt_pk_bf16_f32 v168, v56, v57
v_cvt_pk_bf16_f32 v169, v58, v59
v_cvt_pk_bf16_f32 v170, v60, v61
v_cvt_pk_bf16_f32 v171, v62, v63
v_cvt_pk_bf16_f32 v172, v64, v65
v_cvt_pk_bf16_f32 v173, v66, v67
v_cvt_pk_bf16_f32 v174, v68, v69
v_cvt_pk_bf16_f32 v175, v70, v71
v_mfma_f32_32x32x16_bf16 a[32:47], a[16:19], v[168:171], a[32:47]
s_nop 0
v_mfma_f32_32x32x16_bf16 a[32:47], a[20:23], v[172:175], a[32:47]
v_exp_f32 v88, v88
v_exp_f32 v89, v89
v_exp_f32 v90, v90
v_exp_f32 v91, v91
v_exp_f32 v92, v92
v_exp_f32 v93, v93
v_exp_f32 v94, v94
v_exp_f32 v95, v95
v_exp_f32 v96, v96
v_exp_f32 v97, v97
v_exp_f32 v98, v98
v_exp_f32 v99, v99
v_exp_f32 v100, v100
v_exp_f32 v101, v101
v_exp_f32 v102, v102
v_exp_f32 v103, v103
v_cvt_pk_bf16_f32 v176, v88, v89
v_cvt_pk_bf16_f32 v177, v90, v91
v_cvt_pk_bf16_f32 v178, v92, v93
v_cvt_pk_bf16_f32 v179, v94, v95
v_cvt_pk_bf16_f32 v180, v96, v97
v_cvt_pk_bf16_f32 v181, v98, v99
v_cvt_pk_bf16_f32 v182, v100, v101
v_cvt_pk_bf16_f32 v183, v102, v103
v_mfma_f32_32x32x16_bf16 a[48:63], a[16:19], v[176:179], a[48:63]
s_nop 0
v_mfma_f32_32x32x16_bf16 a[48:63], a[20:23], v[180:183], a[48:63]
s_waitcnt lgkmcnt(0)
v_mfma_f32_32x32x16_bf16 v[88:103], a[4:7], a[132:135], v[120:135]
ds_read_b64_tr_b16 a[8:9], v28 offset:0
ds_read_b64_tr_b16 a[10:11], v28 offset:256
ds_read_b64_tr_b16 a[12:13], v28 offset:512
ds_read_b64_tr_b16 a[14:15], v28 offset:768
v_add_u32 v28, v28, v29
v_exp_f32 v40, v40
v_exp_f32 v41, v41
v_exp_f32 v42, v42
v_exp_f32 v43, v43
v_exp_f32 v44, v44
v_exp_f32 v45, v45
v_exp_f32 v46, v46
v_exp_f32 v47, v47
v_exp_f32 v48, v48
v_exp_f32 v49, v49
v_exp_f32 v50, v50
v_exp_f32 v51, v51
v_exp_f32 v52, v52
v_exp_f32 v53, v53
v_exp_f32 v54, v54
v_exp_f32 v55, v55
v_cvt_pk_bf16_f32 v168, v40, v41
v_cvt_pk_bf16_f32 v169, v42, v43
v_cvt_pk_bf16_f32 v170, v44, v45
v_cvt_pk_bf16_f32 v171, v46, v47
v_cvt_pk_bf16_f32 v172, v48, v49
v_cvt_pk_bf16_f32 v173, v50, v51
v_cvt_pk_bf16_f32 v174, v52, v53
v_cvt_pk_bf16_f32 v175, v54, v55
v_and_b32 v168, v168, v160
v_and_b32 v169, v169, v161
v_and_b32 v170, v170, v162
v_and_b32 v171, v171, v163
v_and_b32 v172, v172, v164
v_and_b32 v173, v173, v165
v_and_b32 v174, v174, v166
v_and_b32 v175, v175, v167
v_mfma_f32_32x32x16_bf16 a[32:47], a[24:27], v[168:171], a[32:47]
s_nop 0
v_mfma_f32_32x32x16_bf16 a[32:47], a[28:31], v[172:175], a[32:47]
v_exp_f32 v72, v72
v_exp_f32 v73, v73
v_exp_f32 v74, v74
v_exp_f32 v75, v75
v_exp_f32 v76, v76
v_exp_f32 v77, v77
v_exp_f32 v78, v78
v_exp_f32 v79, v79
v_exp_f32 v80, v80
v_exp_f32 v81, v81
v_exp_f32 v82, v82
v_exp_f32 v83, v83
v_exp_f32 v84, v84
v_exp_f32 v85, v85
v_exp_f32 v86, v86
v_exp_f32 v87, v87
v_cvt_pk_bf16_f32 v176, v72, v73
v_cvt_pk_bf16_f32 v177, v74, v75
v_cvt_pk_bf16_f32 v178, v76, v77
v_cvt_pk_bf16_f32 v179, v78, v79
v_cvt_pk_bf16_f32 v180, v80, v81
v_cvt_pk_bf16_f32 v181, v82, v83
v_cvt_pk_bf16_f32 v182, v84, v85
v_cvt_pk_bf16_f32 v183, v86, v87
v_mfma_f32_32x32x16_bf16 a[48:63], a[24:27], v[176:179], a[48:63]
s_nop 0
v_mfma_f32_32x32x16_bf16 a[48:63], a[28:31], v[180:183], a[48:63]
v_exp_f32 v88, v88
v_exp_f32 v89, v89
v_exp_f32 v90, v90
v_exp_f32 v91, v91
v_exp_f32 v92, v92
v_exp_f32 v93, v93
v_exp_f32 v94, v94
v_exp_f32 v95, v95
v_exp_f32 v96, v96
v_exp_f32 v97, v97
v_exp_f32 v98, v98
v_exp_f32 v99, v99
v_exp_f32 v100, v100
v_exp_f32 v101, v101
v_exp_f32 v102, v102
v_exp_f32 v103, v103
v_cvt_pk_bf16_f32 v176, v88, v89
v_cvt_pk_bf16_f32 v177, v90, v91
v_cvt_pk_bf16_f32 v178, v92, v93
v_cvt_pk_bf16_f32 v179, v94, v95
v_cvt_pk_bf16_f32 v180, v96, v97
v_cvt_pk_bf16_f32 v181, v98, v99
v_cvt_pk_bf16_f32 v182, v100, v101
v_cvt_pk_bf16_f32 v183, v102, v103
v_and_b32 v176, v176, v160
v_and_b32 v177, v177, v161
v_and_b32 v178, v178, v162
v_and_b32 v179, v179, v163
v_and_b32 v180, v180, v164
v_and_b32 v181, v181, v165
v_and_b32 v182, v182, v166
v_and_b32 v183, v183, v167
s_waitcnt lgkmcnt(0)
v_mfma_f32_32x32x16_bf16 a[48:63], a[8:11], v[176:179], a[48:63]
v_mfma_f32_32x32x16_bf16 a[48:63], a[12:15], v[180:183], a[48:63]
s_nop 7
s_nop 7
s_nop 7
s_branch fbret_21
.section .rodata,"a"
.p2align 6
.amdhsa_kernel recurrent_scan__sliding_block__dense_activation_relu__prompt_kernel
  .amdhsa_next_free_vgpr 512
  .amdhsa_next_free_sgpr 102
  .amdhsa_accum_offset 256
  .amdhsa_group_segment_fixed_size 0
  .amdhsa_kernarg_size 72
  .amdhsa_user_sgpr_count 2
  .amdhsa_user_sgpr_kernarg_segment_ptr 1
  .amdhsa_system_sgpr_workgroup_id_x 1
  .amdhsa_float_denorm_mode_32 3
.end_amdhsa_kernel
.text
```
